```python
import torch

def _softmax(x, axis=-1):
    return torch.softmax(x, dim=axis)
def _gelu(x):
    return torch.nn.functional.gelu(x, approximate="tanh")
def _silu(x):
    return torch.nn.functional.silu(x)
def _sigmoid(x):
    return torch.sigmoid(x)
def _layernorm(x, axis=-1, eps=1e-5):
    m = x.mean(dim=axis, keepdim=True)
    v = x.var(dim=axis, keepdim=True, unbiased=False)
    return (x - m) / torch.sqrt(v + eps)
def _scatter_add(tgt, idx, src, axis=0):
    return tgt.clone().index_add_(axis, idx, src)
def _segment_sum(src, seg, n):
    out = torch.zeros((n,) + src.shape[1:], dtype=src.dtype)
    return out.index_add_(0, seg, src)
def _pad(x, pw):
    flat = tuple(v for pair in reversed(pw) for v in pair)
    return torch.nn.functional.pad(x, flat)

kernel_name = 'parallel_sum__softmax_full_mha__glu_gated_swiglu__prompt'

def setup_inputs():

    _w = (lambda a: (lambda t: t.to(torch.bfloat16) if t.is_floating_point() else t)(torch.as_tensor(a)))
    def _A_setup():
        B, S, D = 1, 2048, 640
        return {
            "x": _w((lambda *s: torch.randn(*s, dtype=torch.bfloat16) * 0.05)(B, S, D)),
            "wqkv": _w((lambda *s: torch.randn(*s, dtype=torch.bfloat16) * 0.05)(D, 3 * D)),
            "wo": _w((lambda *s: torch.randn(*s, dtype=torch.bfloat16) * 0.05)(D, D)),
        }
    _A_in = _A_setup()

    def _B_setup():
        B, S, D, F = 1, 2048, 640, 1536
        return {
            "x": _w((lambda *s: torch.randn(*s, dtype=torch.bfloat16) * 0.05)(B, S, D)),
            "w1": _w((lambda *s: torch.randn(*s, dtype=torch.bfloat16) * 0.4)(D, F) * (2.0 / D) ** 0.5),
            "w3": _w((lambda *s: torch.randn(*s, dtype=torch.bfloat16) * 0.4)(D, F) * (2.0 / D) ** 0.5),
            "w2": _w((lambda *s: torch.randn(*s, dtype=torch.bfloat16) * 0.4)(F, D) * (2.0 / F) ** 0.5),
        }
    _B_in = _B_setup()

    return {
        "A_x": _A_in["x"],
        "A_wqkv": _A_in["wqkv"],
        "A_wo": _A_in["wo"],
        "B_x": _B_in["x"],
        "B_w1": _B_in["w1"],
        "B_w3": _B_in["w3"],
        "B_w2": _B_in["w2"],
    }

def reference(A_x, A_wqkv, A_wo, B_x, B_w1, B_w3, B_w2):
    def _A_ref(x, wqkv, wo):
        B, S, D = x.shape
        H = 32; Dh = D // H
        qkv = (lambda x, *d: x.permute(*d))((x @ wqkv).reshape(B, S, 3, H, Dh), 2, 0, 3, 1, 4)
        q, k, v = qkv[0], qkv[1], qkv[2]
        scale = Dh ** -0.5
        scores = torch.einsum("bhqd,bhkd->bhqk", q, k) * scale
        p = _softmax(scores, axis=-1)
        o = torch.einsum("bhqk,bhkd->bhqd", p, v)
        return (lambda x, *d: x.permute(*d))(o, 0, 2, 1, 3).reshape(B, S, D) @ wo

    def _B_ref(x, w1, w3, w2):
        gate = torch.einsum("bsd,df->bsf", x, w1)
        up = torch.einsum("bsd,df->bsf", x, w3)
        h = _silu(gate) * up
        out = torch.einsum("bsf,fd->bsd", h, w2)
        return out

    x = A_x
    xn = _layernorm(x, axis=-1)
    return x + _A_ref(xn, A_wqkv, A_wo) + _B_ref(xn, B_w1, B_w3, B_w2)
```

```asm
; @launch grid=(256,1,1) block=(768,1,1) lds=157952
.amdgcn_target "amdgcn-amd-amdhsa--gfx950"
.text
.globl parallel_sum__softmax_full_mha__glu_gated_swiglu__prompt_kernel
.p2align 8
.type parallel_sum__softmax_full_mha__glu_gated_swiglu__prompt_kernel,@function
parallel_sum__softmax_full_mha__glu_gated_swiglu__prompt_kernel:
    s_load_dwordx4 s[4:7], s[0:1], 0
    s_load_dwordx4 s[92:95], s[0:1], 64
    s_cmp_ge_u32 s2, 256
    s_cbranch_scc1 parallel_sum__softmax_full_mha__glu_gated_swiglu__prompt_kernel_end
    v_lshrrev_b32 v1, 6, v0
    v_and_b32 v0, 63, v0
    s_and_b32 s3, s2, 3
    s_lshl_b32 s3, s3, 2
    v_readfirstlane_b32 s12, v1
    s_bfe_u32 s15, s2, 0x20003
    s_add_u32 s10, s3, s15
    s_bfe_u32 s3, s2, 0x10002
    s_lshl_b32 s3, s3, 3
    s_lshr_b32 s11, s2, 5
    s_add_u32 s11, s11, s3
    s_lshr_b32 s3, s3, 2
    s_cmp_ge_u32 s2, 224
    s_cselect_b32 s3, s3, 0
    s_xor_b32 s10, s10, s3
    s_cmp_ge_u32 s2, 224
    s_cselect_b32 s11, 7, s11
    s_cmp_ge_u32 s2, 240
    s_cselect_b32 s11, 15, s11
    s_mov_b32 s18, 24940544
    s_mov_b32 s19, 0x00020000
    s_cmp_lt_u32 s12, 4
    s_cbranch_scc1 parallel_sum__softmax_full_mha__glu_gated_swiglu__prompt_kernel_mfma
    s_cmp_lt_u32 s12, 8
    s_cbranch_scc1 parallel_sum__softmax_full_mha__glu_gated_swiglu__prompt_kernel_help
    s_load_dwordx4 s[52:55], s[0:1], 32
    s_load_dwordx2 s[96:97], s[0:1], 48
    s_load_dwordx2 s[100:101], s[0:1], 16
    s_setprio 3
    s_sub_u32 s24, s12, 8
    v_lshrrev_b32 v1, 3, v0
    v_lshrrev_b32 v2, 4, v0
    v_and_b32 v3, 7, v0
    v_xor_b32 v3, v3, v2
    s_lshl_b32 s3, s10, 7
    s_lshl_b32 s29, s24, 5
    s_add_u32 s3, s3, s29
    v_add_u32 v1, s3, v1
    v_mul_u32_u24 v1, 1280, v1
    v_lshl_add_u32 v160, v3, 4, v1
    v_add_u32 v161, 9216, v160
    v_xor_b32 v3, 4, v3
    v_lshl_add_u32 v162, v3, 4, v1
    v_add_u32 v162, 18432, v162
    v_add_u32 v163, 9216, v162
    s_lshl_b32 s3, s24, 4
    v_add_u32 v1, s3, v2
    v_mul_u32_u24 v1, 3840, v1
    v_and_b32 v3, 15, v0
    v_lshlrev_b32 v2, 2, v2
    v_xor_b32 v3, v3, v2
    s_lshl_b32 s3, s11, 8
    v_add_u32 v1, s3, v1
    v_lshl_add_u32 v164, v3, 4, v1
    v_add_u32 v165, 14336, v164
    v_xor_b32 v3, 2, v3
    v_lshl_add_u32 v166, v3, 4, v1
    v_add_u32 v166, 28672, v166
    v_add_u32 v167, 14336, v166
    s_lshl_b32 s34, s24, 12
    s_mov_b32 s8, s34
    s_add_u32 s9, s34, 98304
    s_lshr_b32 s3, s2, 5
    s_mul_i32 s3, s3, 0
    s_mul_i32 s32, s15, 0
    s_add_u32 s32, s32, s3
    s_and_b32 s3, s2, 7
    s_mul_i32 s3, s3, 0
    s_lshr_b32 s3, s3, 0
    s_add_u32 s32, s32, s3
    s_mul_i32 s3, s10, 5
    s_lshr_b32 s3, s3, 4
    s_mul_i32 s3, s3, 2
    s_add_u32 s32, s32, s3
    s_mul_i32 s3, s32, 205
    s_lshr_b32 s3, s3, 11
    s_mul_i32 s3, s3, 10
    s_sub_u32 s32, s32, s3
    s_mul_i32 s33, s32, 245760
    s_lshl_b32 s32, s32, 7
    s_waitcnt lgkmcnt(0)
    s_mov_b32 s48, s4
    s_and_b32 s49, s5, 0xffff
    s_mov_b32 s50, 2621440
    s_mov_b32 s51, 0x00020000
    s_mov_b32 s20, s6
    s_and_b32 s21, s7, 0xffff
    s_mov_b32 s22, 2457600
    s_mov_b32 s23, 0x00020000
    s_cmp_eq_u32 s11, 15
    s_cselect_b32 s50, 0, s50
    s_cselect_b32 s22, 0, s22
    s_add_u32 m0, s34, 16384
    s_nop 0
    buffer_load_dwordx4 v164, s[20:23], s33 offen offset:0 lds
    buffer_load_dwordx4 v165, s[20:23], s33 offen offset:1024 lds
    buffer_load_dwordx4 v166, s[20:23], s33 offen offset:2048 lds
    buffer_load_dwordx4 v167, s[20:23], s33 offen offset:3072 lds
    s_mov_b32 m0, s34
    s_nop 0
    buffer_load_dwordx4 v160, s[48:51], s32 offen offset:0 lds
    buffer_load_dwordx4 v161, s[48:51], s32 offen offset:1024 lds
    buffer_load_dwordx4 v162, s[48:51], s32 offen offset:2048 lds
    buffer_load_dwordx4 v163, s[48:51], s32 offen offset:3072 lds
    s_add_u32 s34, s34, 32768
    s_cmp_eq_u32 s34, s9
    s_cselect_b32 s34, s8, s34
    s_add_u32 s32, s32, 128
    s_add_u32 s33, s33, 245760
    s_cmp_eq_u32 s32, 1280
    s_cselect_b32 s32, 0, s32
    s_cselect_b32 s33, 0, s33
    s_mov_b32 s16, s94
    s_and_b32 s17, s95, 0xffff
    s_lshr_b32 s25, s24, 1
    s_and_b32 s26, s24, 1
    v_lshlrev_b32 v2, 4, v0
    v_lshrrev_b32 v1, 4, v0
    v_and_b32 v4, 15, v0
    v_mov_b32 v18, 0
    s_lshl_b32 s3, s24, 2
    s_add_u32 s3, s3, 155872
    v_mov_b32 v19, s3
    ds_write_b32 v19, v18
    v_mov_b32 v11, 155888
    ds_write_b32 v11, v18
    ds_write_b32 v11, v18 offset:4
    ds_write_b32 v11, v18 offset:16
    v_mov_b32 v12, -1
    ds_write_b32 v11, v12 offset:20
    ds_write_b32 v11, v18 offset:24
    ds_write_b32 v11, v18 offset:28
    ds_write_b32 v11, v18 offset:32
    ds_write_b32 v11, v18 offset:36
    v_and_b32 v11, 7, v0
    v_lshlrev_b32 v11, 2, v11
    v_add_u32 v11, 155840, v11
    ds_write_b32 v11, v18
    s_add_u32 m0, s34, 16384
    s_nop 0
    buffer_load_dwordx4 v164, s[20:23], s33 offen offset:0 lds
    buffer_load_dwordx4 v165, s[20:23], s33 offen offset:1024 lds
    buffer_load_dwordx4 v166, s[20:23], s33 offen offset:2048 lds
    buffer_load_dwordx4 v167, s[20:23], s33 offen offset:3072 lds
    s_mov_b32 m0, s34
    s_nop 0
    buffer_load_dwordx4 v160, s[48:51], s32 offen offset:0 lds
    buffer_load_dwordx4 v161, s[48:51], s32 offen offset:1024 lds
    buffer_load_dwordx4 v162, s[48:51], s32 offen offset:2048 lds
    buffer_load_dwordx4 v163, s[48:51], s32 offen offset:3072 lds
    s_add_u32 s34, s34, 32768
    s_cmp_eq_u32 s34, s9
    s_cselect_b32 s34, s8, s34
    s_add_u32 s32, s32, 128
    s_add_u32 s33, s33, 245760
    s_cmp_eq_u32 s32, 1280
    s_cselect_b32 s32, 0, s32
    s_cselect_b32 s33, 0, s33
    s_waitcnt vmcnt(8) lgkmcnt(0)
    s_barrier
    s_add_u32 m0, s34, 16384
    s_nop 0
    buffer_load_dwordx4 v164, s[20:23], s33 offen offset:0 lds
    buffer_load_dwordx4 v165, s[20:23], s33 offen offset:1024 lds
    buffer_load_dwordx4 v166, s[20:23], s33 offen offset:2048 lds
    buffer_load_dwordx4 v167, s[20:23], s33 offen offset:3072 lds
    s_mov_b32 m0, s34
    s_nop 0
    buffer_load_dwordx4 v160, s[48:51], s32 offen offset:0 lds
    buffer_load_dwordx4 v161, s[48:51], s32 offen offset:1024 lds
    buffer_load_dwordx4 v162, s[48:51], s32 offen offset:2048 lds
    buffer_load_dwordx4 v163, s[48:51], s32 offen offset:3072 lds
    s_add_u32 s34, s34, 32768
    s_cmp_eq_u32 s34, s9
    s_cselect_b32 s34, s8, s34
    s_add_u32 s32, s32, 128
    s_add_u32 s33, s33, 245760
    s_cmp_eq_u32 s32, 1280
    s_cselect_b32 s32, 0, s32
    s_cselect_b32 s33, 0, s33
    v_add_u32 v11, 0, v0
    v_mul_u32_u24 v12, 0xaab, v11
    v_lshrrev_b32 v12, 15, v12
    v_mul_u32_u24 v5, 12, v12
    v_sub_u32 v11, v11, v5
    v_mul_u32_u24 v12, 3072, v12
    v_lshl_add_u32 v5, v11, 4, v12
    v_add_u32 v11, 64, v0
    v_mul_u32_u24 v12, 0xaab, v11
    v_lshrrev_b32 v12, 15, v12
    v_mul_u32_u24 v6, 12, v12
    v_sub_u32 v11, v11, v6
    v_mul_u32_u24 v12, 3072, v12
    v_lshl_add_u32 v6, v11, 4, v12
    v_add_u32 v6, -1024, v6
    v_add_u32 v11, 128, v0
    v_mul_u32_u24 v12, 0xaab, v11
    v_lshrrev_b32 v12, 15, v12
    v_mul_u32_u24 v7, 12, v12
    v_sub_u32 v11, v11, v7
    v_mul_u32_u24 v12, 3072, v12
    v_lshl_add_u32 v7, v11, 4, v12
    v_add_u32 v7, -2048, v7
    s_mov_b32 s4, s11
    s_mov_b32 s5, s10
    s_lshl_b32 s36, s4, 2
    s_add_u32 s36, s36, s24
    s_mul_i32 s36, s36, 40960
    s_add_u32 s36, s36, 7864320
    s_mul_i32 s37, s5, 192
    s_mul_i32 s3, s25, 98304
    s_add_u32 s37, s37, s3
    s_lshl_b32 s38, s24, 12
    s_add_u32 s38, s38, 32768
    s_mul_i32 s39, s26, 12320
    s_mul_i32 s3, s25, 6144
    s_add_u32 s39, s39, s3
    s_add_u32 s39, s39, 49152
    s_mov_b32 s57, 82048
    s_cmp_eq_u32 s26, 0
    s_cselect_b32 s40, s52, s54
    s_cselect_b32 s41, s53, s55
    s_and_b32 s41, s41, 0xffff
    s_mov_b32 s42, 1966080
    s_mov_b32 s43, 0x00020000
    s_mov_b32 s44, s16
    s_mov_b32 s45, s17
    s_mov_b32 s46, 24940544
    s_mov_b32 s47, 0x00020000
    v_and_b32 v20, 3, v0
    v_lshlrev_b32 v20, 2, v20
    v_add_u32 v20, 155872, v20
    v_lshrrev_b32 v11, 3, v0
    v_bfe_u32 v12, v0, 4, 2
    v_lshlrev_b32 v12, 1, v12
    v_and_b32 v22, 7, v0
    v_xor_b32 v12, v12, v22
    v_mul_u32_u24 v11, 1280, v11
    v_lshl_add_u32 v8, v12, 4, v11
    v_add_u32 v9, 9216, v8
    s_lshl_b32 s3, s25, 13
    s_add_u32 s3, s3, 114816
    v_add_u32 v13, s3, v2
    v_bfe_u32 v11, v0, 2, 2
    v_lshl_add_u32 v12, v1, 3, v11
    v_mul_u32_u24 v12, 192, v12
    v_and_b32 v22, 3, v0
    v_lshl_add_u32 v12, v22, 3, v12
    s_mul_i32 s3, s26, 96
    s_add_u32 s3, s3, 131200
    v_add_u32 v14, s3, v12
    s_mul_i32 s15, s24, 30720
    s_add_u32 s15, s15, 32768
    v_add_u32 v15, s15, v2
    v_lshrrev_b32 v12, 2, v0
    v_lshlrev_b32 v12, 7, v12
    v_lshl_add_u32 v12, v22, 3, v12
    v_bfe_u32 v23, v0, 3, 2
    v_lshl_add_u32 v12, v23, 5, v12
    v_add_u32 v16, s15, v12
    v_add_u32 v17, 98304, v2
    s_mov_b32 s14, 82048
    s_and_b32 s97, s97, 0xffff
    s_lshr_b32 s3, s2, 3
    s_lshl_b32 s3, s3, 2
    s_add_u32 s3, s3, s24
    s_and_b32 s101, s101, 0xffff
    s_and_b32 s28, s3, 15
    s_mul_i32 s28, s28, 192
    s_lshr_b32 s31, s3, 4
    s_mul_i32 s31, s31, 98304
    s_add_u32 s28, s28, s31
    s_mul_i32 s98, s3, 137
    s_lshr_b32 s98, s98, 12
    s_mul_i32 s31, s98, 30
    s_sub_u32 s3, s3, s31
    s_lshl_b32 s3, s3, 12
    s_mul_i32 s98, s98, 491520
    s_add_u32 s98, s98, s3
    v_mov_b32 v22, 155892
    s_mov_b32 s59, 0
    v_and_b32 v11, 15, v0
    v_lshlrev_b32 v11, 4, v11
    s_mov_b32 s35, 99
    v_mov_b32 v24, 0
    v_mov_b32 v25, 0
    v_mov_b32 v26, 0
    v_mov_b32 v27, 0
    s_nop 0
    s_nop 0
    v_mfma_f32_32x32x16_bf16 v[64:79], v[24:27], v[24:27], 0
    v_mfma_f32_32x32x16_bf16 v[80:95], v[24:27], v[24:27], 0
    v_mfma_f32_32x32x16_bf16 v[96:111], v[24:27], v[24:27], 0
    v_mfma_f32_32x32x16_bf16 v[112:127], v[24:27], v[24:27], 0
    v_mfma_f32_32x32x16_bf16 v[128:143], v[24:27], v[24:27], 0
    v_mfma_f32_32x32x16_bf16 v[144:159], v[24:27], v[24:27], 0
    s_cmp_eq_u32 s11, 15
    s_cbranch_scc1 parallel_sum__softmax_full_mha__glu_gated_swiglu__prompt_kernel_fidle
    s_mov_b32 s13, 6
    s_waitcnt vmcnt(8)
    s_barrier
parallel_sum__softmax_full_mha__glu_gated_swiglu__prompt_kernel_lloop:
    s_add_u32 m0, s34, 16384
    s_nop 0
    buffer_load_dwordx4 v164, s[20:23], s33 offen offset:0 lds
    buffer_load_dwordx4 v165, s[20:23], s33 offen offset:1024 lds
    buffer_load_dwordx4 v166, s[20:23], s33 offen offset:2048 lds
    buffer_load_dwordx4 v167, s[20:23], s33 offen offset:3072 lds
    s_mov_b32 m0, s34
    s_nop 0
    buffer_load_dwordx4 v160, s[48:51], s32 offen offset:0 lds
    buffer_load_dwordx4 v161, s[48:51], s32 offen offset:1024 lds
    buffer_load_dwordx4 v162, s[48:51], s32 offen offset:2048 lds
    buffer_load_dwordx4 v163, s[48:51], s32 offen offset:3072 lds
    s_add_u32 s34, s34, 32768
    s_cmp_eq_u32 s34, s9
    s_cselect_b32 s34, s8, s34
    s_add_u32 s32, s32, 128
    s_add_u32 s33, s33, 245760
    s_cmp_eq_u32 s32, 1280
    s_cselect_b32 s32, 0, s32
    s_cselect_b32 s33, 0, s33
    s_waitcnt vmcnt(8) lgkmcnt(0)
    s_barrier
    s_sub_u32 s13, s13, 1
    s_cmp_lg_u32 s13, 0
    s_cbranch_scc1 parallel_sum__softmax_full_mha__glu_gated_swiglu__prompt_kernel_lloop
    v_mov_b32 v12, 155900
    ds_read_b32 v12, v12
    s_waitcnt lgkmcnt(0)
    v_readfirstlane_b32 s99, v12
    s_add_u32 m0, s34, 16384
    s_nop 0
    buffer_load_dwordx4 v164, s[20:23], s33 offen offset:0 lds
    buffer_load_dwordx4 v165, s[20:23], s33 offen offset:1024 lds
    buffer_load_dwordx4 v166, s[20:23], s33 offen offset:2048 lds
    buffer_load_dwordx4 v167, s[20:23], s33 offen offset:3072 lds
    s_mov_b32 m0, s34
    s_nop 0
    buffer_load_dwordx4 v160, s[48:51], s32 offen offset:0 lds
    buffer_load_dwordx4 v161, s[48:51], s32 offen offset:1024 lds
    buffer_load_dwordx4 v162, s[48:51], s32 offen offset:2048 lds
    buffer_load_dwordx4 v163, s[48:51], s32 offen offset:3072 lds
    s_add_u32 s34, s34, 32768
    s_cmp_eq_u32 s34, s9
    s_cselect_b32 s34, s8, s34
    s_add_u32 s32, s32, 128
    s_add_u32 s33, s33, 245760
    s_cmp_eq_u32 s32, 1280
    s_cselect_b32 s32, 0, s32
    s_cselect_b32 s33, 0, s33
    s_waitcnt vmcnt(8)
    s_barrier
parallel_sum__softmax_full_mha__glu_gated_swiglu__prompt_kernel_pa_r:
    s_add_u32 m0, s39, s57
    s_nop 0
    buffer_load_dwordx4 v5, s[40:43], s37 offen offset:0 lds
    buffer_load_dwordx4 v6, s[40:43], s37 offen offset:1024 lds
    buffer_load_dwordx4 v7, s[40:43], s37 offen offset:2048 lds
    s_add_u32 m0, m0, 3072
    s_add_u32 s58, s37, 49152
    buffer_load_dwordx4 v5, s[40:43], s58 offen offset:0 lds
    buffer_load_dwordx4 v6, s[40:43], s58 offen offset:1024 lds
    buffer_load_dwordx4 v7, s[40:43], s58 offen offset:2048 lds
    s_add_u32 m0, s38, s57
    s_nop 0
    buffer_load_dwordx4 v2, s[44:47], s36 offen offset:0 sc1 lds
    buffer_load_dwordx4 v2, s[44:47], s36 offen offset:1024 sc1 lds
    buffer_load_dwordx4 v2, s[44:47], s36 offen offset:2048 sc1 lds
    buffer_load_dwordx4 v2, s[44:47], s36 offen offset:3072 sc1 lds
    s_add_u32 s36, s36, 4096
    s_add_u32 s37, s37, 196608
    s_sub_u32 s57, s57, 41024
    s_cselect_b32 s57, 82048, s57
    s_waitcnt vmcnt(10)
    s_cmp_eq_u32 s11, 15
    s_cbranch_scc1 parallel_sum__softmax_full_mha__glu_gated_swiglu__prompt_kernel_f9a
    s_barrier
parallel_sum__softmax_full_mha__glu_gated_swiglu__prompt_kernel_f9a:
    s_add_u32 m0, s39, s57
    s_nop 0
    buffer_load_dwordx4 v5, s[40:43], s37 offen offset:0 lds
    buffer_load_dwordx4 v6, s[40:43], s37 offen offset:1024 lds
    buffer_load_dwordx4 v7, s[40:43], s37 offen offset:2048 lds
    s_add_u32 m0, m0, 3072
    s_add_u32 s58, s37, 49152
    buffer_load_dwordx4 v5, s[40:43], s58 offen offset:0 lds
    buffer_load_dwordx4 v6, s[40:43], s58 offen offset:1024 lds
    buffer_load_dwordx4 v7, s[40:43], s58 offen offset:2048 lds
    s_add_u32 m0, s38, s57
    s_nop 0
    buffer_load_dwordx4 v2, s[44:47], s36 offen offset:0 sc1 lds
    buffer_load_dwordx4 v2, s[44:47], s36 offen offset:1024 sc1 lds
    buffer_load_dwordx4 v2, s[44:47], s36 offen offset:2048 sc1 lds
    buffer_load_dwordx4 v2, s[44:47], s36 offen offset:3072 sc1 lds
    s_add_u32 s36, s36, 4096
    s_add_u32 s37, s37, 196608
    s_sub_u32 s57, s57, 41024
    s_cselect_b32 s57, 82048, s57
    s_cmp_eq_u32 s11, 15
    s_cbranch_scc1 parallel_sum__softmax_full_mha__glu_gated_swiglu__prompt_kernel_f9
    s_barrier
    s_barrier
parallel_sum__softmax_full_mha__glu_gated_swiglu__prompt_kernel_f9:
    s_setprio 1
    s_mov_b32 s56, 0
    s_waitcnt vmcnt(10)
    v_add_u32 v18, 1, v18
    ds_write_b32 v19, v18
    ds_read_b32 v21, v20
    s_waitcnt lgkmcnt(0)
    v_cmp_lt_u32 vcc, v21, v18
    s_cbranch_vccnz parallel_sum__softmax_full_mha__glu_gated_swiglu__prompt_kernel_fb0s
parallel_sum__softmax_full_mha__glu_gated_swiglu__prompt_kernel_fb0r:
    ds_read_b64_tr_b16 v[56:57], v14 offset:0
    ds_read_b64_tr_b16 v[58:59], v14 offset:768
    ds_read_b128 v[24:27], v13 offset:0
    ds_read_b128 v[28:31], v13 offset:1024
    ds_read_b128 v[32:35], v13 offset:4096
    ds_read_b128 v[36:39], v13 offset:5120
    ds_read_b64_tr_b16 v[60:61], v14 offset:12320
    ds_read_b64_tr_b16 v[62:63], v14 offset:13088
    s_mov_b32 s13, 10
    s_waitcnt lgkmcnt(2)
    v_mfma_f32_16x16x32_bf16 v[64:67], v[56:59], v[24:27], v[64:67]
    ds_read_b64_tr_b16 v[160:161], v14 offset:32
    v_mfma_f32_16x16x32_bf16 v[68:71], v[56:59], v[28:31], v[68:71]
    ds_read_b64_tr_b16 v[162:163], v14 offset:800
    v_mfma_f32_16x16x32_bf16 v[72:75], v[56:59], v[32:35], v[72:75]
    v_mfma_f32_16x16x32_bf16 v[76:79], v[56:59], v[36:39], v[76:79]
    s_waitcnt lgkmcnt(2)
    v_mfma_f32_16x16x32_bf16 v[80:83], v[60:63], v[24:27], v[80:83]
    ds_read_b64_tr_b16 v[56:57], v14 offset:12352
    v_mfma_f32_16x16x32_bf16 v[84:87], v[60:63], v[28:31], v[84:87]
    ds_read_b64_tr_b16 v[58:59], v14 offset:13120
    v_mfma_f32_16x16x32_bf16 v[88:91], v[60:63], v[32:35], v[88:91]
    v_mfma_f32_16x16x32_bf16 v[92:95], v[60:63], v[36:39], v[92:95]
    s_waitcnt lgkmcnt(2)
    v_mfma_f32_16x16x32_bf16 v[96:99], v[160:163], v[24:27], v[96:99]
    ds_read_b64_tr_b16 v[60:61], v14 offset:64
    v_mfma_f32_16x16x32_bf16 v[100:103], v[160:163], v[28:31], v[100:103]
    ds_read_b64_tr_b16 v[62:63], v14 offset:832
    v_mfma_f32_16x16x32_bf16 v[104:107], v[160:163], v[32:35], v[104:107]
    v_mfma_f32_16x16x32_bf16 v[108:111], v[160:163], v[36:39], v[108:111]
    s_waitcnt lgkmcnt(2)
    v_mfma_f32_16x16x32_bf16 v[112:115], v[56:59], v[24:27], v[112:115]
    ds_read_b64_tr_b16 v[160:161], v14 offset:12384
    v_mfma_f32_16x16x32_bf16 v[116:119], v[56:59], v[28:31], v[116:119]
    ds_read_b64_tr_b16 v[162:163], v14 offset:13152
    v_mfma_f32_16x16x32_bf16 v[120:123], v[56:59], v[32:35], v[120:123]
    v_mfma_f32_16x16x32_bf16 v[124:127], v[56:59], v[36:39], v[124:127]
    s_waitcnt lgkmcnt(2)
    v_mfma_f32_16x16x32_bf16 v[128:131], v[60:63], v[24:27], v[128:131]
    ds_read_b64_tr_b16 v[56:57], v14 offset:6144
    v_mfma_f32_16x16x32_bf16 v[132:135], v[60:63], v[28:31], v[132:135]
    ds_read_b64_tr_b16 v[58:59], v14 offset:6912
    v_mfma_f32_16x16x32_bf16 v[136:139], v[60:63], v[32:35], v[136:139]
    ds_read_b128 v[40:43], v13 offset:2048
    v_mfma_f32_16x16x32_bf16 v[140:143], v[60:63], v[36:39], v[140:143]
    ds_read_b128 v[44:47], v13 offset:3072
    s_waitcnt lgkmcnt(4)
    v_mfma_f32_16x16x32_bf16 v[144:147], v[160:163], v[24:27], v[144:147]
    ds_read_b128 v[48:51], v13 offset:6144
    v_mfma_f32_16x16x32_bf16 v[148:151], v[160:163], v[28:31], v[148:151]
    ds_read_b128 v[52:55], v13 offset:7168
    v_mfma_f32_16x16x32_bf16 v[152:155], v[160:163], v[32:35], v[152:155]
    ds_read_b64_tr_b16 v[60:61], v14 offset:18464
    v_mfma_f32_16x16x32_bf16 v[156:159], v[160:163], v[36:39], v[156:159]
    ds_read_b64_tr_b16 v[62:63], v14 offset:19232
    s_waitcnt lgkmcnt(2)
    v_mfma_f32_16x16x32_bf16 v[64:67], v[56:59], v[40:43], v[64:67]
    ds_read_b64_tr_b16 v[160:161], v14 offset:6176
    v_mfma_f32_16x16x32_bf16 v[68:71], v[56:59], v[44:47], v[68:71]
    ds_read_b64_tr_b16 v[162:163], v14 offset:6944
    v_mfma_f32_16x16x32_bf16 v[72:75], v[56:59], v[48:51], v[72:75]
    v_mfma_f32_16x16x32_bf16 v[76:79], v[56:59], v[52:55], v[76:79]
    s_waitcnt lgkmcnt(2)
    v_mfma_f32_16x16x32_bf16 v[80:83], v[60:63], v[40:43], v[80:83]
    ds_read_b64_tr_b16 v[56:57], v14 offset:18496
    v_mfma_f32_16x16x32_bf16 v[84:87], v[60:63], v[44:47], v[84:87]
    ds_read_b64_tr_b16 v[58:59], v14 offset:19264
    v_mfma_f32_16x16x32_bf16 v[88:91], v[60:63], v[48:51], v[88:91]
    v_mfma_f32_16x16x32_bf16 v[92:95], v[60:63], v[52:55], v[92:95]
    s_waitcnt lgkmcnt(2)
    v_mfma_f32_16x16x32_bf16 v[96:99], v[160:163], v[40:43], v[96:99]
    ds_read_b64_tr_b16 v[60:61], v14 offset:6208
    v_mfma_f32_16x16x32_bf16 v[100:103], v[160:163], v[44:47], v[100:103]
    ds_read_b64_tr_b16 v[62:63], v14 offset:6976
    v_mfma_f32_16x16x32_bf16 v[104:107], v[160:163], v[48:51], v[104:107]
    v_mfma_f32_16x16x32_bf16 v[108:111], v[160:163], v[52:55], v[108:111]
    s_waitcnt lgkmcnt(2)
    v_mfma_f32_16x16x32_bf16 v[112:115], v[56:59], v[40:43], v[112:115]
    ds_read_b64_tr_b16 v[160:161], v14 offset:18528
    v_mfma_f32_16x16x32_bf16 v[116:119], v[56:59], v[44:47], v[116:119]
    ds_read_b64_tr_b16 v[162:163], v14 offset:19296
    v_mfma_f32_16x16x32_bf16 v[120:123], v[56:59], v[48:51], v[120:123]
    v_mfma_f32_16x16x32_bf16 v[124:127], v[56:59], v[52:55], v[124:127]
parallel_sum__softmax_full_mha__glu_gated_swiglu__prompt_kernel_fp_l:
    s_sleep 2
    ds_read_b32 v23, v22 offset:28
    s_waitcnt lgkmcnt(0)
    v_cmp_gt_u32 vcc, 4, v23
    s_cmp_eq_u32 s11, 15
    s_cbranch_scc1 parallel_sum__softmax_full_mha__glu_gated_swiglu__prompt_kernel_fp_r
    s_cbranch_vccnz parallel_sum__softmax_full_mha__glu_gated_swiglu__prompt_kernel_fp_l
parallel_sum__softmax_full_mha__glu_gated_swiglu__prompt_kernel_fp_r:
    s_add_u32 m0, s39, s57
    s_nop 0
    buffer_load_dwordx4 v5, s[40:43], s37 offen offset:0 lds
    buffer_load_dwordx4 v6, s[40:43], s37 offen offset:1024 lds
    buffer_load_dwordx4 v7, s[40:43], s37 offen offset:2048 lds
    s_add_u32 m0, m0, 3072
    s_add_u32 s58, s37, 49152
    buffer_load_dwordx4 v5, s[40:43], s58 offen offset:0 lds
    buffer_load_dwordx4 v6, s[40:43], s58 offen offset:1024 lds
    buffer_load_dwordx4 v7, s[40:43], s58 offen offset:2048 lds
    s_add_u32 m0, s38, s57
    s_nop 0
    buffer_load_dwordx4 v2, s[44:47], s36 offen offset:0 sc1 lds
    buffer_load_dwordx4 v2, s[44:47], s36 offen offset:1024 sc1 lds
    buffer_load_dwordx4 v2, s[44:47], s36 offen offset:2048 sc1 lds
    buffer_load_dwordx4 v2, s[44:47], s36 offen offset:3072 sc1 lds
    s_add_u32 s36, s36, 4096
    s_add_u32 s37, s37, 196608
    s_sub_u32 s57, s57, 41024
    s_cselect_b32 s57, 82048, s57
    s_branch parallel_sum__softmax_full_mha__glu_gated_swiglu__prompt_kernel_upmid
.p2align 6
parallel_sum__softmax_full_mha__glu_gated_swiglu__prompt_kernel_uploop:
    s_cmp_le_u32 s13, 2
    s_cselect_b32 s42, 819200, s42
    s_cselect_b32 s40, s100, s40
    s_cselect_b32 s41, s101, s41
    s_cselect_b32 s37, s28, s37
    s_cselect_b32 s31, 786432, 0
    s_cselect_b32 s46, 1966080, s46
    s_cselect_b32 s44, s96, s44
    s_cselect_b32 s45, s97, s45
    s_cselect_b32 s36, s98, s36
    s_cselect_b32 s3, 122880, 0
    s_add_u32 s98, s98, s3
    s_add_u32 s28, s28, s31
    s_waitcnt lgkmcnt(2)
    v_mfma_f32_16x16x32_bf16 v[64:67], v[56:59], v[24:27], v[64:67]
    ds_read_b64_tr_b16 v[160:161], v14 offset:32
    v_mfma_f32_16x16x32_bf16 v[68:71], v[56:59], v[28:31], v[68:71]
    ds_read_b64_tr_b16 v[162:163], v14 offset:800
    v_mfma_f32_16x16x32_bf16 v[72:75], v[56:59], v[32:35], v[72:75]
    s_add_u32 m0, s39, s57
    s_nop 0
    buffer_load_dwordx4 v5, s[40:43], s37 offen offset:0 lds
    v_mfma_f32_16x16x32_bf16 v[76:79], v[56:59], v[36:39], v[76:79]
    s_waitcnt lgkmcnt(2)
    v_mfma_f32_16x16x32_bf16 v[80:83], v[60:63], v[24:27], v[80:83]
    ds_read_b64_tr_b16 v[56:57], v14 offset:12352
    v_mfma_f32_16x16x32_bf16 v[84:87], v[60:63], v[28:31], v[84:87]
    ds_read_b64_tr_b16 v[58:59], v14 offset:13120
    v_mfma_f32_16x16x32_bf16 v[88:91], v[60:63], v[32:35], v[88:91]
    buffer_load_dwordx4 v6, s[40:43], s37 offen offset:1024 lds
    v_mfma_f32_16x16x32_bf16 v[92:95], v[60:63], v[36:39], v[92:95]
    s_waitcnt lgkmcnt(2)
    v_mfma_f32_16x16x32_bf16 v[96:99], v[160:163], v[24:27], v[96:99]
    ds_read_b64_tr_b16 v[60:61], v14 offset:64
    v_mfma_f32_16x16x32_bf16 v[100:103], v[160:163], v[28:31], v[100:103]
    ds_read_b64_tr_b16 v[62:63], v14 offset:832
    v_mfma_f32_16x16x32_bf16 v[104:107], v[160:163], v[32:35], v[104:107]
    buffer_load_dwordx4 v7, s[40:43], s37 offen offset:2048 lds
    v_mfma_f32_16x16x32_bf16 v[108:111], v[160:163], v[36:39], v[108:111]
    s_waitcnt lgkmcnt(2)
    v_mfma_f32_16x16x32_bf16 v[112:115], v[56:59], v[24:27], v[112:115]
    ds_read_b64_tr_b16 v[160:161], v14 offset:12384
    v_mfma_f32_16x16x32_bf16 v[116:119], v[56:59], v[28:31], v[116:119]
    ds_read_b64_tr_b16 v[162:163], v14 offset:13152
    v_mfma_f32_16x16x32_bf16 v[120:123], v[56:59], v[32:35], v[120:123]
    s_add_u32 m0, m0, 3072
    s_add_u32 s58, s37, 49152
    buffer_load_dwordx4 v5, s[40:43], s58 offen offset:0 lds
    v_mfma_f32_16x16x32_bf16 v[124:127], v[56:59], v[36:39], v[124:127]
    s_waitcnt lgkmcnt(2)
    v_mfma_f32_16x16x32_bf16 v[128:131], v[60:63], v[24:27], v[128:131]
    ds_read_b64_tr_b16 v[56:57], v14 offset:6144
    v_mfma_f32_16x16x32_bf16 v[132:135], v[60:63], v[28:31], v[132:135]
    ds_read_b64_tr_b16 v[58:59], v14 offset:6912
    v_mfma_f32_16x16x32_bf16 v[136:139], v[60:63], v[32:35], v[136:139]
    ds_read_b128 v[40:43], v13 offset:2048
    buffer_load_dwordx4 v6, s[40:43], s58 offen offset:1024 lds
    v_mfma_f32_16x16x32_bf16 v[140:143], v[60:63], v[36:39], v[140:143]
    ds_read_b128 v[44:47], v13 offset:3072
    s_waitcnt lgkmcnt(4)
    v_mfma_f32_16x16x32_bf16 v[144:147], v[160:163], v[24:27], v[144:147]
    ds_read_b128 v[48:51], v13 offset:6144
    v_mfma_f32_16x16x32_bf16 v[148:151], v[160:163], v[28:31], v[148:151]
    ds_read_b128 v[52:55], v13 offset:7168
    v_mfma_f32_16x16x32_bf16 v[152:155], v[160:163], v[32:35], v[152:155]
    ds_read_b64_tr_b16 v[60:61], v14 offset:18464
    buffer_load_dwordx4 v7, s[40:43], s58 offen offset:2048 lds
    v_mfma_f32_16x16x32_bf16 v[156:159], v[160:163], v[36:39], v[156:159]
    ds_read_b64_tr_b16 v[62:63], v14 offset:19232
    s_waitcnt lgkmcnt(2)
    v_mfma_f32_16x16x32_bf16 v[64:67], v[56:59], v[40:43], v[64:67]
    ds_read_b64_tr_b16 v[160:161], v14 offset:6176
    v_mfma_f32_16x16x32_bf16 v[68:71], v[56:59], v[44:47], v[68:71]
    ds_read_b64_tr_b16 v[162:163], v14 offset:6944
    v_mfma_f32_16x16x32_bf16 v[72:75], v[56:59], v[48:51], v[72:75]
    s_add_u32 m0, s38, s57
    s_nop 0
    buffer_load_dwordx4 v2, s[44:47], s36 offen offset:0 sc1 lds
    v_mfma_f32_16x16x32_bf16 v[76:79], v[56:59], v[52:55], v[76:79]
    s_waitcnt lgkmcnt(2)
    v_mfma_f32_16x16x32_bf16 v[80:83], v[60:63], v[40:43], v[80:83]
    ds_read_b64_tr_b16 v[56:57], v14 offset:18496
    v_mfma_f32_16x16x32_bf16 v[84:87], v[60:63], v[44:47], v[84:87]
    ds_read_b64_tr_b16 v[58:59], v14 offset:19264
    v_mfma_f32_16x16x32_bf16 v[88:91], v[60:63], v[48:51], v[88:91]
    buffer_load_dwordx4 v2, s[44:47], s36 offen offset:1024 sc1 lds
    v_mfma_f32_16x16x32_bf16 v[92:95], v[60:63], v[52:55], v[92:95]
    s_waitcnt lgkmcnt(2)
    v_mfma_f32_16x16x32_bf16 v[96:99], v[160:163], v[40:43], v[96:99]
    ds_read_b64_tr_b16 v[60:61], v14 offset:6208
    v_mfma_f32_16x16x32_bf16 v[100:103], v[160:163], v[44:47], v[100:103]
    ds_read_b64_tr_b16 v[62:63], v14 offset:6976
    v_mfma_f32_16x16x32_bf16 v[104:107], v[160:163], v[48:51], v[104:107]
    buffer_load_dwordx4 v2, s[44:47], s36 offen offset:2048 sc1 lds
    v_mfma_f32_16x16x32_bf16 v[108:111], v[160:163], v[52:55], v[108:111]
    s_waitcnt lgkmcnt(2)
    v_mfma_f32_16x16x32_bf16 v[112:115], v[56:59], v[40:43], v[112:115]
    ds_read_b64_tr_b16 v[160:161], v14 offset:18528
    v_mfma_f32_16x16x32_bf16 v[116:119], v[56:59], v[44:47], v[116:119]
    ds_read_b64_tr_b16 v[162:163], v14 offset:19296
    v_mfma_f32_16x16x32_bf16 v[120:123], v[56:59], v[48:51], v[120:123]
    buffer_load_dwordx4 v2, s[44:47], s36 offen offset:3072 sc1 lds
    s_add_u32 s36, s36, 4096
    s_add_u32 s37, s37, 196608
    s_sub_u32 s57, s57, 41024
    s_cselect_b32 s57, 82048, s57
    v_mfma_f32_16x16x32_bf16 v[124:127], v[56:59], v[52:55], v[124:127]
parallel_sum__softmax_full_mha__glu_gated_swiglu__prompt_kernel_upmid:
    s_sub_u32 s3, s14, 41024
    s_cselect_b32 s3, 82048, s3
    s_sub_u32 s27, s3, s14
    s_mov_b32 s14, s3
    s_setprio 3
    v_add_u32 v13, s27, v13
    v_add_u32 v14, s27, v14
    s_cmp_eq_u32 s56, 0
    s_cbranch_scc1 parallel_sum__softmax_full_mha__glu_gated_swiglu__prompt_kernel_gsync
    s_add_u32 s3, s59, s13
    s_cmp_gt_u32 s3, s35
    s_cbranch_scc1 parallel_sum__softmax_full_mha__glu_gated_swiglu__prompt_kernel_csync
    s_mov_b32 s35, 99
    s_setprio 0
    s_waitcnt vmcnt(10) lgkmcnt(0)
    s_barrier
    s_add_u32 s59, s59, 1
parallel_sum__softmax_full_mha__glu_gated_swiglu__prompt_kernel_gback:
    v_mfma_f32_16x16x32_bf16 v[128:131], v[60:63], v[40:43], v[128:131]
    ds_read_b64_tr_b16 v[56:57], v14 offset:0
    v_mfma_f32_16x16x32_bf16 v[132:135], v[60:63], v[44:47], v[132:135]
    ds_read_b64_tr_b16 v[58:59], v14 offset:768
    v_mfma_f32_16x16x32_bf16 v[136:139], v[60:63], v[48:51], v[136:139]
    ds_read_b128 v[24:27], v13 offset:0
    v_mfma_f32_16x16x32_bf16 v[140:143], v[60:63], v[52:55], v[140:143]
    ds_read_b128 v[28:31], v13 offset:1024
    s_waitcnt lgkmcnt(4)
    v_mfma_f32_16x16x32_bf16 v[144:147], v[160:163], v[40:43], v[144:147]
    ds_read_b128 v[32:35], v13 offset:4096
    v_mfma_f32_16x16x32_bf16 v[148:151], v[160:163], v[44:47], v[148:151]
    ds_read_b128 v[36:39], v13 offset:5120
    v_mfma_f32_16x16x32_bf16 v[152:155], v[160:163], v[48:51], v[152:155]
    ds_read_b64_tr_b16 v[60:61], v14 offset:12320
    v_mfma_f32_16x16x32_bf16 v[156:159], v[160:163], v[52:55], v[156:159]
    ds_read_b64_tr_b16 v[62:63], v14 offset:13088
    s_sub_u32 s13, s13, 1
    s_cmp_lg_u32 s13, 0
    s_cbranch_scc1 parallel_sum__softmax_full_mha__glu_gated_swiglu__prompt_kernel_uploop
    s_setprio 3
    s_load_dwordx2 s[52:53], s[0:1], 48
    s_load_dwordx2 s[92:93], s[0:1], 0
    s_load_dwordx2 s[94:95], s[0:1], 16
    s_load_dwordx2 s[96:97], s[0:1], 56
    s_mov_b32 s40, 0x40053526
    s_lshl_b32 s3, s4, 2
    s_lshl_b32 s36, s25, 1
    s_add_u32 s3, s3, s36
    s_mul_i32 s36, s3, 96
    s_mul_i32 s3, s5, 6
    s_add_u32 s36, s36, s3
    s_mul_i32 s3, s26, 3
    s_add_u32 s36, s36, s3
    s_lshl_b32 s36, s36, 10
    s_add_u32 s36, s36, 10485760
    s_add_u32 s37, s36, 98304
    s_waitcnt lgkmcnt(0)
    s_mov_b32 s48, s52
    s_and_b32 s49, s53, 0xffff
    s_mov_b32 s50, 1966080
    s_mov_b32 s51, 0x00020000
    v_exp_f32 v24, -v64
    v_exp_f32 v25, -v65
    v_exp_f32 v26, -v66
    v_exp_f32 v27, -v67
    v_exp_f32 v28, -v68
    v_exp_f32 v29, -v69
    v_exp_f32 v30, -v70
    v_exp_f32 v31, -v71
    v_mul_f32 v64, v64, v80
    v_mul_f32 v65, v65, v81
    v_mul_f32 v66, v66, v82
    v_mul_f32 v67, v67, v83
    v_mul_f32 v68, v68, v84
    v_mul_f32 v69, v69, v85
    v_mul_f32 v70, v70, v86
    v_mul_f32 v71, v71, v87
    v_fma_f32 v24, v24, s40, s40
    v_fma_f32 v25, v25, s40, s40
    v_fma_f32 v26, v26, s40, s40
    v_fma_f32 v27, v27, s40, s40
    v_fma_f32 v28, v28, s40, s40
    v_fma_f32 v29, v29, s40, s40
    v_fma_f32 v30, v30, s40, s40
    v_fma_f32 v31, v31, s40, s40
    v_rcp_f32 v24, v24
    v_rcp_f32 v25, v25
    v_rcp_f32 v26, v26
    v_rcp_f32 v27, v27
    v_rcp_f32 v28, v28
    v_rcp_f32 v29, v29
    v_rcp_f32 v30, v30
    v_rcp_f32 v31, v31
    v_mul_f32 v64, v64, v24
    v_mul_f32 v65, v65, v25
    v_mul_f32 v66, v66, v26
    v_mul_f32 v67, v67, v27
    v_mul_f32 v68, v68, v28
    v_mul_f32 v69, v69, v29
    v_mul_f32 v70, v70, v30
    v_mul_f32 v71, v71, v31
    v_cvt_pk_bf16_f32 v80, v64, v65
    v_cvt_pk_bf16_f32 v81, v66, v67
    v_cvt_pk_bf16_f32 v82, v68, v69
    v_cvt_pk_bf16_f32 v83, v70, v71
    buffer_store_dwordx4 v[80:83], v2, s[16:19], s36 offen offset:0 sc1
    v_exp_f32 v32, -v72
    v_exp_f32 v33, -v73
    v_exp_f32 v34, -v74
    v_exp_f32 v35, -v75
    v_exp_f32 v36, -v76
    v_exp_f32 v37, -v77
    v_exp_f32 v38, -v78
    v_exp_f32 v39, -v79
    v_mul_f32 v72, v72, v88
    v_mul_f32 v73, v73, v89
    v_mul_f32 v74, v74, v90
    v_mul_f32 v75, v75, v91
    v_mul_f32 v76, v76, v92
    v_mul_f32 v77, v77, v93
    v_mul_f32 v78, v78, v94
    v_mul_f32 v79, v79, v95
    v_fma_f32 v32, v32, s40, s40
    v_fma_f32 v33, v33, s40, s40
    v_fma_f32 v34, v34, s40, s40
    v_fma_f32 v35, v35, s40, s40
    v_fma_f32 v36, v36, s40, s40
    v_fma_f32 v37, v37, s40, s40
    v_fma_f32 v38, v38, s40, s40
    v_fma_f32 v39, v39, s40, s40
    v_rcp_f32 v32, v32
    v_rcp_f32 v33, v33
    v_rcp_f32 v34, v34
    v_rcp_f32 v35, v35
    v_rcp_f32 v36, v36
    v_rcp_f32 v37, v37
    v_rcp_f32 v38, v38
    v_rcp_f32 v39, v39
    v_mul_f32 v72, v72, v32
    v_mul_f32 v73, v73, v33
    v_mul_f32 v74, v74, v34
    v_mul_f32 v75, v75, v35
    v_mul_f32 v76, v76, v36
    v_mul_f32 v77, v77, v37
    v_mul_f32 v78, v78, v38
    v_mul_f32 v79, v79, v39
    v_cvt_pk_bf16_f32 v88, v72, v73
    v_cvt_pk_bf16_f32 v89, v74, v75
    v_cvt_pk_bf16_f32 v90, v76, v77
    v_cvt_pk_bf16_f32 v91, v78, v79
    buffer_store_dwordx4 v[88:91], v2, s[16:19], s37 offen offset:0 sc1
    v_exp_f32 v24, -v96
    v_exp_f32 v25, -v97
    v_exp_f32 v26, -v98
    v_exp_f32 v27, -v99
    v_exp_f32 v28, -v100
    v_exp_f32 v29, -v101
    v_exp_f32 v30, -v102
    v_exp_f32 v31, -v103
    v_mul_f32 v96, v96, v112
    v_mul_f32 v97, v97, v113
    v_mul_f32 v98, v98, v114
    v_mul_f32 v99, v99, v115
    v_mul_f32 v100, v100, v116
    v_mul_f32 v101, v101, v117
    v_mul_f32 v102, v102, v118
    v_mul_f32 v103, v103, v119
    v_fma_f32 v24, v24, s40, s40
    v_fma_f32 v25, v25, s40, s40
    v_fma_f32 v26, v26, s40, s40
    v_fma_f32 v27, v27, s40, s40
    v_fma_f32 v28, v28, s40, s40
    v_fma_f32 v29, v29, s40, s40
    v_fma_f32 v30, v30, s40, s40
    v_fma_f32 v31, v31, s40, s40
    v_rcp_f32 v24, v24
    v_rcp_f32 v25, v25
    v_rcp_f32 v26, v26
    v_rcp_f32 v27, v27
    v_rcp_f32 v28, v28
    v_rcp_f32 v29, v29
    v_rcp_f32 v30, v30
    v_rcp_f32 v31, v31
    v_mul_f32 v96, v96, v24
    v_mul_f32 v97, v97, v25
    v_mul_f32 v98, v98, v26
    v_mul_f32 v99, v99, v27
    v_mul_f32 v100, v100, v28
    v_mul_f32 v101, v101, v29
    v_mul_f32 v102, v102, v30
    v_mul_f32 v103, v103, v31
    v_cvt_pk_bf16_f32 v112, v96, v97
    v_cvt_pk_bf16_f32 v113, v98, v99
    v_cvt_pk_bf16_f32 v114, v100, v101
    v_cvt_pk_bf16_f32 v115, v102, v103
    buffer_store_dwordx4 v[112:115], v2, s[16:19], s36 offen offset:1024 sc1
    v_exp_f32 v32, -v104
    v_exp_f32 v33, -v105
    v_exp_f32 v34, -v106
    v_exp_f32 v35, -v107
    v_exp_f32 v36, -v108
    v_exp_f32 v37, -v109
    v_exp_f32 v38, -v110
    v_exp_f32 v39, -v111
    v_mul_f32 v104, v104, v120
    v_mul_f32 v105, v105, v121
    v_mul_f32 v106, v106, v122
    v_mul_f32 v107, v107, v123
    v_mul_f32 v108, v108, v124
    v_mul_f32 v109, v109, v125
    v_mul_f32 v110, v110, v126
    v_mul_f32 v111, v111, v127
    v_fma_f32 v32, v32, s40, s40
    v_fma_f32 v33, v33, s40, s40
    v_fma_f32 v34, v34, s40, s40
    v_fma_f32 v35, v35, s40, s40
    v_fma_f32 v36, v36, s40, s40
    v_fma_f32 v37, v37, s40, s40
    v_fma_f32 v38, v38, s40, s40
    v_fma_f32 v39, v39, s40, s40
    v_rcp_f32 v32, v32
    v_rcp_f32 v33, v33
    v_rcp_f32 v34, v34
    v_rcp_f32 v35, v35
    v_rcp_f32 v36, v36
    v_rcp_f32 v37, v37
    v_rcp_f32 v38, v38
    v_rcp_f32 v39, v39
    v_mul_f32 v104, v104, v32
    v_mul_f32 v105, v105, v33
    v_mul_f32 v106, v106, v34
    v_mul_f32 v107, v107, v35
    v_mul_f32 v108, v108, v36
    v_mul_f32 v109, v109, v37
    v_mul_f32 v110, v110, v38
    v_mul_f32 v111, v111, v39
    v_cvt_pk_bf16_f32 v120, v104, v105
    v_cvt_pk_bf16_f32 v121, v106, v107
    v_cvt_pk_bf16_f32 v122, v108, v109
    v_cvt_pk_bf16_f32 v123, v110, v111
    buffer_store_dwordx4 v[120:123], v2, s[16:19], s37 offen offset:1024 sc1
    v_exp_f32 v24, -v128
    v_exp_f32 v25, -v129
    v_exp_f32 v26, -v130
    v_exp_f32 v27, -v131
    v_exp_f32 v28, -v132
    v_exp_f32 v29, -v133
    v_exp_f32 v30, -v134
    v_exp_f32 v31, -v135
    v_mul_f32 v128, v128, v144
    v_mul_f32 v129, v129, v145
    v_mul_f32 v130, v130, v146
    v_mul_f32 v131, v131, v147
    v_mul_f32 v132, v132, v148
    v_mul_f32 v133, v133, v149
    v_mul_f32 v134, v134, v150
    v_mul_f32 v135, v135, v151
    v_fma_f32 v24, v24, s40, s40
    v_fma_f32 v25, v25, s40, s40
    v_fma_f32 v26, v26, s40, s40
    v_fma_f32 v27, v27, s40, s40
    v_fma_f32 v28, v28, s40, s40
    v_fma_f32 v29, v29, s40, s40
    v_fma_f32 v30, v30, s40, s40
    v_fma_f32 v31, v31, s40, s40
    v_rcp_f32 v24, v24
    v_rcp_f32 v25, v25
    v_rcp_f32 v26, v26
    v_rcp_f32 v27, v27
    v_rcp_f32 v28, v28
    v_rcp_f32 v29, v29
    v_rcp_f32 v30, v30
    v_rcp_f32 v31, v31
    v_mul_f32 v128, v128, v24
    v_mul_f32 v129, v129, v25
    v_mul_f32 v130, v130, v26
    v_mul_f32 v131, v131, v27
    v_mul_f32 v132, v132, v28
    v_mul_f32 v133, v133, v29
    v_mul_f32 v134, v134, v30
    v_mul_f32 v135, v135, v31
    v_cvt_pk_bf16_f32 v144, v128, v129
    v_cvt_pk_bf16_f32 v145, v130, v131
    v_cvt_pk_bf16_f32 v146, v132, v133
    v_cvt_pk_bf16_f32 v147, v134, v135
    buffer_store_dwordx4 v[144:147], v2, s[16:19], s36 offen offset:2048 sc1
    v_exp_f32 v32, -v136
    v_exp_f32 v33, -v137
    v_exp_f32 v34, -v138
    v_exp_f32 v35, -v139
    v_exp_f32 v36, -v140
    v_exp_f32 v37, -v141
    v_exp_f32 v38, -v142
    v_exp_f32 v39, -v143
    v_mul_f32 v136, v136, v152
    v_mul_f32 v137, v137, v153
    v_mul_f32 v138, v138, v154
    v_mul_f32 v139, v139, v155
    v_mul_f32 v140, v140, v156
    v_mul_f32 v141, v141, v157
    v_mul_f32 v142, v142, v158
    v_mul_f32 v143, v143, v159
    v_fma_f32 v32, v32, s40, s40
    v_fma_f32 v33, v33, s40, s40
    v_fma_f32 v34, v34, s40, s40
    v_fma_f32 v35, v35, s40, s40
    v_fma_f32 v36, v36, s40, s40
    v_fma_f32 v37, v37, s40, s40
    v_fma_f32 v38, v38, s40, s40
    v_fma_f32 v39, v39, s40, s40
    v_rcp_f32 v32, v32
    v_rcp_f32 v33, v33
    v_rcp_f32 v34, v34
    v_rcp_f32 v35, v35
    v_rcp_f32 v36, v36
    v_rcp_f32 v37, v37
    v_rcp_f32 v38, v38
    v_rcp_f32 v39, v39
    v_mul_f32 v136, v136, v32
    v_mul_f32 v137, v137, v33
    v_mul_f32 v138, v138, v34
    v_mul_f32 v139, v139, v35
    v_mul_f32 v140, v140, v36
    v_mul_f32 v141, v141, v37
    v_mul_f32 v142, v142, v38
    v_mul_f32 v143, v143, v39
    v_cvt_pk_bf16_f32 v152, v136, v137
    v_cvt_pk_bf16_f32 v153, v138, v139
    v_cvt_pk_bf16_f32 v154, v140, v141
    v_cvt_pk_bf16_f32 v155, v142, v143
    buffer_store_dwordx4 v[152:155], v2, s[16:19], s37 offen offset:2048 sc1
    s_waitcnt vmcnt(6)
    v_add_u32 v18, 1, v18
    ds_write_b32 v19, v18
    ds_read_b32 v21, v20
    s_lshl_b32 s3, s4, 4
    s_add_u32 s3, s3, s5
    s_lshl_b32 s3, s3, 4
    s_add_u32 s55, s3, 24903680
    s_mov_b32 s9, s2
    s_cmp_ge_u32 s2, 240
    s_cselect_b32 s3, 0, 0
    s_sub_u32 s9, s9, s3
    s_cmp_eq_u32 s11, 99
    s_cselect_b32 s9, 255, s9
    s_lshr_b32 s3, s9, 3
    s_cmp_ge_u32 s3, 30
    s_cselect_b32 s50, 0, s50
    s_mul_i32 s58, s3, 26
    s_lshr_b32 s58, s58, 8
    s_mul_i32 s7, s58, 10
    s_sub_u32 s7, s3, s7
    s_cmp_eq_u32 s58, 2
    s_cselect_b32 s27, 0x70000000, 0
    s_mul_i32 s58, s58, 3
    s_and_b32 s6, s9, 7
    s_lshl_b32 s6, s6, 3
    s_add_u32 s6, s6, s58
    s_mul_i32 s37, s24, 491520
    s_lshl_b32 s3, s7, 7
    s_add_u32 s37, s37, s3
    s_mul_i32 s36, s6, 96
    s_mul_i32 s3, s24, 24
    s_add_u32 s36, s36, s3
    s_lshl_b32 s36, s36, 10
    s_add_u32 s36, s36, 10485760
    s_and_b32 s3, s9, 7
    s_lshl_b32 s3, s3, 9
    s_lshl_b32 s39, s24, 6
    s_add_u32 s39, s39, s3
    s_add_u32 s39, s39, 24903680
    v_add_u32 v10, 196608, v2
    v_add_u32 v10, s27, v10
    s_waitcnt lgkmcnt(0)
    v_cmp_lt_u32 vcc, v21, v18
    s_cbranch_vccnz parallel_sum__softmax_full_mha__glu_gated_swiglu__prompt_kernel_fb1s
parallel_sum__softmax_full_mha__glu_gated_swiglu__prompt_kernel_fb1r:
    s_add_u32 m0, s15, 0
    s_nop 0
    buffer_load_dwordx4 v8, s[48:51], s37 offen lds
    buffer_load_dwordx4 v9, s[48:51], s37 offen offset:1024 lds
    s_add_u32 s37, s37, 20480
    s_add_u32 m0, s15, 5120
    s_nop 0
    buffer_load_dwordx4 v8, s[48:51], s37 offen lds
    buffer_load_dwordx4 v9, s[48:51], s37 offen offset:1024 lds
    s_add_u32 s37, s37, 20480
    s_add_u32 m0, s15, 10240
    s_nop 0
    buffer_load_dwordx4 v8, s[48:51], s37 offen lds
    buffer_load_dwordx4 v9, s[48:51], s37 offen offset:1024 lds
    s_add_u32 s37, s37, 20480
    s_setprio 0
    s_cmp_ge_u32 s59, s56
    s_cbranch_scc1 parallel_sum__softmax_full_mha__glu_gated_swiglu__prompt_kernel_cb0
    s_barrier
    s_add_u32 s59, s59, 1
parallel_sum__softmax_full_mha__glu_gated_swiglu__prompt_kernel_cb0:
    s_setprio 3
    s_waitcnt vmcnt(6)
    s_mov_b64 exec, 1
    v_mov_b32 v24, 155912
    v_mov_b32 v25, 1
    ds_add_rtn_u32 v25, v24, v25
    v_mov_b32 v24, 0
    v_mov_b32 v26, s99
    s_waitcnt lgkmcnt(0)
    v_cmp_eq_u32 vcc, 3, v25
    s_cbranch_vccz parallel_sum__softmax_full_mha__glu_gated_swiglu__prompt_kernel_sg0
    buffer_store_dword v26, v24, s[16:19], s55 offen sc1
parallel_sum__softmax_full_mha__glu_gated_swiglu__prompt_kernel_sg0:
    s_mov_b64 exec, -1
    s_lshr_b32 s3, s9, 3
    s_cmp_ge_u32 s3, 30
    s_cbranch_scc1 parallel_sum__softmax_full_mha__glu_gated_swiglu__prompt_kernel_pf2
    s_add_u32 m0, s15, 15360
    s_nop 0
    buffer_load_dwordx4 v8, s[48:51], s37 offen lds
    buffer_load_dwordx4 v9, s[48:51], s37 offen offset:1024 lds
    s_add_u32 s37, s37, 20480
    s_add_u32 m0, s15, 20480
    s_nop 0
    buffer_load_dwordx4 v8, s[48:51], s37 offen lds
    buffer_load_dwordx4 v9, s[48:51], s37 offen offset:1024 lds
    s_add_u32 s37, s37, 20480
    s_add_u32 m0, s15, 25600
    s_nop 0
    buffer_load_dwordx4 v8, s[48:51], s37 offen lds
    buffer_load_dwordx4 v9, s[48:51], s37 offen offset:1024 lds
    s_add_u32 s37, s37, 20480
    v_and_b32 v11, 3, v0
    v_lshlrev_b32 v11, 4, v11
    v_bfe_u32 v12, v0, 2, 1
    v_lshl_add_u32 v11, v12, 8, v11
    s_mov_b32 s44, s94
    s_and_b32 s45, s95, 0xffff
    s_mov_b32 s46, 819200
    s_mov_b32 s47, 0x00020000
    s_mul_i32 s38, s24, 204800
    s_lshl_b32 s3, s7, 7
    s_add_u32 s38, s38, s3
    s_mov_b32 s56, 16
    s_mov_b32 s13, 0x100000
parallel_sum__softmax_full_mha__glu_gated_swiglu__prompt_kernel_hp_l:
    buffer_load_dword v12, v11, s[16:19], s39 offen sc1
    s_cmp_ge_u32 s59, s56
    s_cbranch_scc1 parallel_sum__softmax_full_mha__glu_gated_swiglu__prompt_kernel_cb1
    s_barrier
    s_add_u32 s59, s59, 1
parallel_sum__softmax_full_mha__glu_gated_swiglu__prompt_kernel_cb1:
    s_sub_u32 s13, s13, 1
    s_cmp_eq_u32 s13, 0
    s_cbranch_scc1 parallel_sum__softmax_full_mha__glu_gated_swiglu__prompt_kernel_hp_r
    s_waitcnt vmcnt(0)
    v_cmp_ne_u32 vcc, s99, v12
    s_cbranch_vccz parallel_sum__softmax_full_mha__glu_gated_swiglu__prompt_kernel_hp_r
    buffer_load_dword v12, v11, s[16:19], s39 offen sc1
    s_waitcnt vmcnt(0)
    v_cmp_ne_u32 vcc, s99, v12
    s_cbranch_vccnz parallel_sum__softmax_full_mha__glu_gated_swiglu__prompt_kernel_hp_l
parallel_sum__softmax_full_mha__glu_gated_swiglu__prompt_kernel_hp_r:
    s_waitcnt vmcnt(0)
    s_add_u32 s58, s36, 0
    s_add_u32 m0, s15, 2048
    s_nop 0
    buffer_load_dwordx4 v2, s[16:19], s58 offen offset:0 sc1 lds
    s_add_u32 s58, s36, 0
    s_add_u32 m0, s15, 3072
    s_nop 0
    buffer_load_dwordx4 v17, s[16:19], s58 offen offset:0 sc1 lds
    s_add_u32 s58, s36, 0
    s_add_u32 m0, s15, 4096
    s_nop 0
    buffer_load_dwordx4 v10, s[16:19], s58 offen offset:0 sc1 lds
    s_add_u32 s58, s36, 0
    s_add_u32 m0, s15, 6144
    s_nop 0
    buffer_load_dwordx4 v2, s[16:19], s58 offen offset:1024 sc1 lds
    s_add_u32 s58, s36, 0
    s_add_u32 m0, s15, 7168
    s_nop 0
    buffer_load_dwordx4 v17, s[16:19], s58 offen offset:1024 sc1 lds
    s_add_u32 s58, s36, 0
    s_add_u32 m0, s15, 8192
    s_nop 0
    buffer_load_dwordx4 v10, s[16:19], s58 offen offset:1024 sc1 lds
    s_add_u32 s58, s36, 0
    s_add_u32 m0, s15, 10240
    s_nop 0
    buffer_load_dwordx4 v2, s[16:19], s58 offen offset:2048 sc1 lds
    s_add_u32 s58, s36, 0
    s_add_u32 m0, s15, 11264
    s_nop 0
    buffer_load_dwordx4 v17, s[16:19], s58 offen offset:2048 sc1 lds
    s_add_u32 s58, s36, 0
    s_add_u32 m0, s15, 12288
    s_nop 0
    buffer_load_dwordx4 v10, s[16:19], s58 offen offset:2048 sc1 lds
    s_add_u32 s58, s36, 0
    s_add_u32 m0, s15, 14336
    s_nop 0
    buffer_load_dwordx4 v2, s[16:19], s58 offen offset:3072 sc1 lds
    s_add_u32 s58, s36, 0
    s_add_u32 m0, s15, 15360
    s_nop 0
    buffer_load_dwordx4 v17, s[16:19], s58 offen offset:3072 sc1 lds
    s_add_u32 s58, s36, 0
    s_add_u32 m0, s15, 16384
    s_nop 0
    buffer_load_dwordx4 v10, s[16:19], s58 offen offset:3072 sc1 lds
    v_xor_b32 v5, 32, v16
    v_xor_b32 v6, 64, v16
    v_xor_b32 v7, 0x60, v16
    v_add_u32 v13, 8, v15
    v_and_b32 v11, 7, v0
    v_lshlrev_b32 v11, 4, v11
    s_lshl_b32 s3, s24, 3
    s_and_b32 s39, s9, 7
    s_lshl_b32 s39, s39, 5
    s_add_u32 s39, s39, s3
    s_lshl_b32 s39, s39, 4
    s_add_u32 s39, s39, 19398656
    s_setprio 0
    s_waitcnt vmcnt(6)
    ds_read_b64_tr_b16 v[24:25], v16 offset:0
    ds_read_b64_tr_b16 v[26:27], v16 offset:5120
    ds_read_b64_tr_b16 v[28:29], v5 offset:0
    ds_read_b64_tr_b16 v[30:31], v5 offset:5120
    ds_read_b64_tr_b16 v[32:33], v6 offset:0
    ds_read_b64_tr_b16 v[34:35], v6 offset:5120
    ds_read_b64_tr_b16 v[36:37], v7 offset:0
    ds_read_b64_tr_b16 v[38:39], v7 offset:5120
    ds_read2st64_b64 v[56:59], v15 offset0:4 offset1:14
    ds_read2st64_b64 v[60:63], v13 offset0:4 offset1:14
    s_waitcnt lgkmcnt(1)
    v_mfma_f32_16x16x32_bf16 v[64:67], v[24:27], v[56:59], 0
    ds_read2st64_b64 v[160:163], v15 offset0:6 offset1:16
    s_add_u32 s58, s36, 4096
    s_add_u32 m0, s15, 22528
    s_nop 0
    buffer_load_dwordx4 v2, s[16:19], s58 offen offset:0 sc1 lds
    v_mfma_f32_16x16x32_bf16 v[68:71], v[28:31], v[56:59], 0
    s_add_u32 s58, s36, 4096
    s_add_u32 m0, s15, 26624
    s_nop 0
    buffer_load_dwordx4 v2, s[16:19], s58 offen offset:1024 sc1 lds
    v_mfma_f32_16x16x32_bf16 v[72:75], v[32:35], v[56:59], 0
    s_add_u32 s58, s36, 4096
    s_add_u32 m0, s15, 23552
    s_nop 0
    buffer_load_dwordx4 v17, s[16:19], s58 offen offset:0 sc1 lds
    v_mfma_f32_16x16x32_bf16 v[76:79], v[36:39], v[56:59], 0
    s_add_u32 s58, s36, 4096
    s_add_u32 m0, s15, 27648
    s_nop 0
    buffer_load_dwordx4 v17, s[16:19], s58 offen offset:1024 sc1 lds
    s_waitcnt lgkmcnt(1)
    v_mfma_f32_16x16x32_bf16 v[80:83], v[24:27], v[60:63], 0
    ds_read2st64_b64 v[56:59], v13 offset0:6 offset1:16
    s_add_u32 s58, s36, 4096
    s_add_u32 m0, s15, 24576
    s_nop 0
    buffer_load_dwordx4 v10, s[16:19], s58 offen offset:0 sc1 lds
    v_mfma_f32_16x16x32_bf16 v[84:87], v[28:31], v[60:63], 0
    s_add_u32 s58, s36, 4096
    s_add_u32 m0, s15, 28672
    s_nop 0
    buffer_load_dwordx4 v10, s[16:19], s58 offen offset:1024 sc1 lds
    v_mfma_f32_16x16x32_bf16 v[88:91], v[32:35], v[60:63], 0
    s_add_u32 m0, s15, 0
    s_nop 0
    buffer_load_dwordx4 v8, s[48:51], s37 offen lds
    v_mfma_f32_16x16x32_bf16 v[92:95], v[36:39], v[60:63], 0
    buffer_load_dwordx4 v9, s[48:51], s37 offen offset:1024 lds
    s_add_u32 s37, s37, 20480
    s_waitcnt lgkmcnt(1)
    v_mfma_f32_16x16x32_bf16 v[96:99], v[24:27], v[160:163], 0
    ds_read2st64_b64 v[60:63], v15 offset0:8 offset1:18
    v_mfma_f32_16x16x32_bf16 v[100:103], v[28:31], v[160:163], 0
    s_add_u32 m0, s15, 5120
    s_nop 0
    buffer_load_dwordx4 v8, s[48:51], s37 offen lds
    v_mfma_f32_16x16x32_bf16 v[104:107], v[32:35], v[160:163], 0
    v_mfma_f32_16x16x32_bf16 v[108:111], v[36:39], v[160:163], 0
    buffer_load_dwordx4 v9, s[48:51], s37 offen offset:1024 lds
    s_add_u32 s37, s37, 20480
    s_waitcnt lgkmcnt(1)
    v_mfma_f32_16x16x32_bf16 v[112:115], v[24:27], v[56:59], 0
    ds_read2st64_b64 v[160:163], v13 offset0:8 offset1:18
    v_mfma_f32_16x16x32_bf16 v[116:119], v[28:31], v[56:59], 0
    s_add_u32 s58, s36, 4096
    s_add_u32 m0, s15, 0
    s_nop 0
    buffer_load_dwordx4 v2, s[16:19], s58 offen offset:2048 sc1 lds
    v_mfma_f32_16x16x32_bf16 v[120:123], v[32:35], v[56:59], 0
    v_mfma_f32_16x16x32_bf16 v[124:127], v[36:39], v[56:59], 0
    s_add_u32 s58, s36, 4096
    s_add_u32 m0, s15, 4096
    s_nop 0
    buffer_load_dwordx4 v2, s[16:19], s58 offen offset:3072 sc1 lds
    s_waitcnt vmcnt(12)
    s_waitcnt lgkmcnt(1)
    v_mfma_f32_16x16x32_bf16 v[128:131], v[24:27], v[60:63], 0
    ds_read_b64_tr_b16 v[40:41], v16 offset:10240
    ds_read_b64_tr_b16 v[42:43], v16 offset:15360
    v_mfma_f32_16x16x32_bf16 v[132:135], v[28:31], v[60:63], 0
    ds_read_b64_tr_b16 v[44:45], v5 offset:10240
    s_add_u32 s58, s36, 4096
    s_add_u32 m0, s15, 1024
    s_nop 0
    buffer_load_dwordx4 v17, s[16:19], s58 offen offset:2048 sc1 lds
    v_mfma_f32_16x16x32_bf16 v[136:139], v[32:35], v[60:63], 0
    ds_read_b64_tr_b16 v[46:47], v5 offset:15360
    v_mfma_f32_16x16x32_bf16 v[140:143], v[36:39], v[60:63], 0
    ds_read2st64_b64 v[56:59], v15 offset0:24 offset1:34
    s_waitcnt lgkmcnt(5)
    v_mfma_f32_16x16x32_bf16 v[144:147], v[24:27], v[160:163], 0
    ds_read_b64_tr_b16 v[48:49], v6 offset:10240
    ds_read_b64_tr_b16 v[50:51], v6 offset:15360
    v_mfma_f32_16x16x32_bf16 v[148:151], v[28:31], v[160:163], 0
    ds_read_b64_tr_b16 v[52:53], v7 offset:10240
    s_add_u32 s58, s36, 4096
    s_add_u32 m0, s15, 5120
    s_nop 0
    buffer_load_dwordx4 v17, s[16:19], s58 offen offset:3072 sc1 lds
    v_mfma_f32_16x16x32_bf16 v[152:155], v[32:35], v[160:163], 0
    ds_read_b64_tr_b16 v[54:55], v7 offset:15360
    v_mfma_f32_16x16x32_bf16 v[156:159], v[36:39], v[160:163], 0
    ds_read2st64_b64 v[60:63], v13 offset0:24 offset1:34
    s_cmp_ge_u32 s59, s56
    s_cbranch_scc1 parallel_sum__softmax_full_mha__glu_gated_swiglu__prompt_kernel_cb2
    s_barrier
    s_add_u32 s59, s59, 1
parallel_sum__softmax_full_mha__glu_gated_swiglu__prompt_kernel_cb2:
    s_waitcnt lgkmcnt(1)
    v_mfma_f32_16x16x32_bf16 v[64:67], v[40:43], v[56:59], v[64:67]
    ds_read2st64_b64 v[160:163], v15 offset0:26 offset1:36
    v_mfma_f32_16x16x32_bf16 v[68:71], v[44:47], v[56:59], v[68:71]
    s_add_u32 s58, s36, 4096
    s_add_u32 m0, s15, 2048
    s_nop 0
    buffer_load_dwordx4 v10, s[16:19], s58 offen offset:2048 sc1 lds
    v_mfma_f32_16x16x32_bf16 v[72:75], v[48:51], v[56:59], v[72:75]
    v_mfma_f32_16x16x32_bf16 v[76:79], v[52:55], v[56:59], v[76:79]
    s_add_u32 s58, s36, 4096
    s_add_u32 m0, s15, 6144
    s_nop 0
    buffer_load_dwordx4 v10, s[16:19], s58 offen offset:3072 sc1 lds
    s_waitcnt lgkmcnt(1)
    v_mfma_f32_16x16x32_bf16 v[80:83], v[40:43], v[60:63], v[80:83]
    ds_read2st64_b64 v[56:59], v13 offset0:26 offset1:36
    v_mfma_f32_16x16x32_bf16 v[84:87], v[44:47], v[60:63], v[84:87]
    s_add_u32 m0, s15, 10240
    s_nop 0
    buffer_load_dwordx4 v8, s[48:51], s37 offen lds
    v_mfma_f32_16x16x32_bf16 v[88:91], v[48:51], v[60:63], v[88:91]
    v_mfma_f32_16x16x32_bf16 v[92:95], v[52:55], v[60:63], v[92:95]
    buffer_load_dwordx4 v9, s[48:51], s37 offen offset:1024 lds
    s_add_u32 s37, s37, 20480
    s_waitcnt lgkmcnt(1)
    v_mfma_f32_16x16x32_bf16 v[96:99], v[40:43], v[160:163], v[96:99]
    ds_read2st64_b64 v[60:63], v15 offset0:28 offset1:38
    v_mfma_f32_16x16x32_bf16 v[100:103], v[44:47], v[160:163], v[100:103]
    s_add_u32 m0, s15, 15360
    s_nop 0
    buffer_load_dwordx4 v8, s[48:51], s37 offen lds
    v_mfma_f32_16x16x32_bf16 v[104:107], v[48:51], v[160:163], v[104:107]
    v_mfma_f32_16x16x32_bf16 v[108:111], v[52:55], v[160:163], v[108:111]
    buffer_load_dwordx4 v9, s[48:51], s37 offen offset:1024 lds
    s_add_u32 s37, s37, 20480
    s_waitcnt lgkmcnt(1)
    v_mfma_f32_16x16x32_bf16 v[112:115], v[40:43], v[56:59], v[112:115]
    ds_read2st64_b64 v[160:163], v13 offset0:28 offset1:38
    v_mfma_f32_16x16x32_bf16 v[116:119], v[44:47], v[56:59], v[116:119]
    s_add_u32 s58, s36, 8192
    s_add_u32 m0, s15, 12288
    s_nop 0
    buffer_load_dwordx4 v2, s[16:19], s58 offen offset:0 sc1 lds
    v_mfma_f32_16x16x32_bf16 v[120:123], v[48:51], v[56:59], v[120:123]
    v_mfma_f32_16x16x32_bf16 v[124:127], v[52:55], v[56:59], v[124:127]
    s_add_u32 s58, s36, 8192
    s_add_u32 m0, s15, 16384
    s_nop 0
    buffer_load_dwordx4 v2, s[16:19], s58 offen offset:1024 sc1 lds
    s_waitcnt vmcnt(16)
    s_waitcnt lgkmcnt(1)
    v_mfma_f32_16x16x32_bf16 v[128:131], v[40:43], v[60:63], v[128:131]
    ds_read_b64_tr_b16 v[24:25], v16 offset:20480
    ds_read_b64_tr_b16 v[26:27], v16 offset:25600
    v_mfma_f32_16x16x32_bf16 v[132:135], v[44:47], v[60:63], v[132:135]
    ds_read_b64_tr_b16 v[28:29], v5 offset:20480
    s_add_u32 s58, s36, 8192
    s_add_u32 m0, s15, 13312
    s_nop 0
    buffer_load_dwordx4 v17, s[16:19], s58 offen offset:0 sc1 lds
    v_mfma_f32_16x16x32_bf16 v[136:139], v[48:51], v[60:63], v[136:139]
    ds_read_b64_tr_b16 v[30:31], v5 offset:25600
    v_mfma_f32_16x16x32_bf16 v[140:143], v[52:55], v[60:63], v[140:143]
    ds_read2st64_b64 v[56:59], v15 offset0:44 offset1:54
    s_waitcnt lgkmcnt(5)
    v_mfma_f32_16x16x32_bf16 v[144:147], v[40:43], v[160:163], v[144:147]
    ds_read_b64_tr_b16 v[32:33], v6 offset:20480
    ds_read_b64_tr_b16 v[34:35], v6 offset:25600
    v_mfma_f32_16x16x32_bf16 v[148:151], v[44:47], v[160:163], v[148:151]
    ds_read_b64_tr_b16 v[36:37], v7 offset:20480
    s_add_u32 s58, s36, 8192
    s_add_u32 m0, s15, 17408
    s_nop 0
    buffer_load_dwordx4 v17, s[16:19], s58 offen offset:1024 sc1 lds
    v_mfma_f32_16x16x32_bf16 v[152:155], v[48:51], v[160:163], v[152:155]
    ds_read_b64_tr_b16 v[38:39], v7 offset:25600
    v_mfma_f32_16x16x32_bf16 v[156:159], v[52:55], v[160:163], v[156:159]
    ds_read2st64_b64 v[60:63], v13 offset0:44 offset1:54
    s_cmp_ge_u32 s59, s56
    s_cbranch_scc1 parallel_sum__softmax_full_mha__glu_gated_swiglu__prompt_kernel_cb3
    s_barrier
    s_add_u32 s59, s59, 1
parallel_sum__softmax_full_mha__glu_gated_swiglu__prompt_kernel_cb3:
    s_waitcnt lgkmcnt(1)
    v_mfma_f32_16x16x32_bf16 v[64:67], v[24:27], v[56:59], v[64:67]
    ds_read2st64_b64 v[160:163], v15 offset0:46 offset1:56
    v_mfma_f32_16x16x32_bf16 v[68:71], v[28:31], v[56:59], v[68:71]
    s_add_u32 s58, s36, 8192
    s_add_u32 m0, s15, 14336
    s_nop 0
    buffer_load_dwordx4 v10, s[16:19], s58 offen offset:0 sc1 lds
    v_mfma_f32_16x16x32_bf16 v[72:75], v[32:35], v[56:59], v[72:75]
    v_mfma_f32_16x16x32_bf16 v[76:79], v[36:39], v[56:59], v[76:79]
    s_add_u32 s58, s36, 8192
    s_add_u32 m0, s15, 18432
    s_nop 0
    buffer_load_dwordx4 v10, s[16:19], s58 offen offset:1024 sc1 lds
    s_waitcnt lgkmcnt(1)
    v_mfma_f32_16x16x32_bf16 v[80:83], v[24:27], v[60:63], v[80:83]
    ds_read2st64_b64 v[56:59], v13 offset0:46 offset1:56
    v_mfma_f32_16x16x32_bf16 v[84:87], v[28:31], v[60:63], v[84:87]
    s_add_u32 m0, s15, 20480
    s_nop 0
    buffer_load_dwordx4 v8, s[48:51], s37 offen lds
    v_mfma_f32_16x16x32_bf16 v[88:91], v[32:35], v[60:63], v[88:91]
    v_mfma_f32_16x16x32_bf16 v[92:95], v[36:39], v[60:63], v[92:95]
    buffer_load_dwordx4 v9, s[48:51], s37 offen offset:1024 lds
    s_add_u32 s37, s37, 20480
    s_waitcnt lgkmcnt(1)
    v_mfma_f32_16x16x32_bf16 v[96:99], v[24:27], v[160:163], v[96:99]
    ds_read2st64_b64 v[60:63], v15 offset0:48 offset1:58
    v_mfma_f32_16x16x32_bf16 v[100:103], v[28:31], v[160:163], v[100:103]
    s_add_u32 m0, s15, 25600
    s_nop 0
    buffer_load_dwordx4 v8, s[48:51], s37 offen lds
    v_mfma_f32_16x16x32_bf16 v[104:107], v[32:35], v[160:163], v[104:107]
    v_mfma_f32_16x16x32_bf16 v[108:111], v[36:39], v[160:163], v[108:111]
    buffer_load_dwordx4 v9, s[48:51], s37 offen offset:1024 lds
    s_add_u32 s37, s37, 20480
    s_waitcnt lgkmcnt(1)
    v_mfma_f32_16x16x32_bf16 v[112:115], v[24:27], v[56:59], v[112:115]
    ds_read2st64_b64 v[160:163], v13 offset0:48 offset1:58
    v_mfma_f32_16x16x32_bf16 v[116:119], v[28:31], v[56:59], v[116:119]
    s_add_u32 s58, s36, 8192
    s_add_u32 m0, s15, 20480
    s_nop 0
    buffer_load_dwordx4 v2, s[16:19], s58 offen offset:2048 sc1 lds
    v_mfma_f32_16x16x32_bf16 v[120:123], v[32:35], v[56:59], v[120:123]
    v_mfma_f32_16x16x32_bf16 v[124:127], v[36:39], v[56:59], v[124:127]
    s_add_u32 s58, s36, 8192
    s_add_u32 m0, s15, 24576
    s_nop 0
    buffer_load_dwordx4 v2, s[16:19], s58 offen offset:3072 sc1 lds
    s_waitcnt vmcnt(16)
    s_waitcnt lgkmcnt(1)
    v_mfma_f32_16x16x32_bf16 v[128:131], v[24:27], v[60:63], v[128:131]
    ds_read_b64_tr_b16 v[40:41], v16 offset:0
    ds_read_b64_tr_b16 v[42:43], v16 offset:5120
    v_mfma_f32_16x16x32_bf16 v[132:135], v[28:31], v[60:63], v[132:135]
    ds_read_b64_tr_b16 v[44:45], v5 offset:0
    s_add_u32 s58, s36, 8192
    s_add_u32 m0, s15, 21504
    s_nop 0
    buffer_load_dwordx4 v17, s[16:19], s58 offen offset:2048 sc1 lds
    v_mfma_f32_16x16x32_bf16 v[136:139], v[32:35], v[60:63], v[136:139]
    ds_read_b64_tr_b16 v[46:47], v5 offset:5120
    v_mfma_f32_16x16x32_bf16 v[140:143], v[36:39], v[60:63], v[140:143]
    ds_read2st64_b64 v[56:59], v15 offset0:4 offset1:14
    s_waitcnt lgkmcnt(5)
    v_mfma_f32_16x16x32_bf16 v[144:147], v[24:27], v[160:163], v[144:147]
    ds_read_b64_tr_b16 v[48:49], v6 offset:0
    ds_read_b64_tr_b16 v[50:51], v6 offset:5120
    v_mfma_f32_16x16x32_bf16 v[148:151], v[28:31], v[160:163], v[148:151]
    ds_read_b64_tr_b16 v[52:53], v7 offset:0
    s_add_u32 s58, s36, 8192
    s_add_u32 m0, s15, 25600
    s_nop 0
    buffer_load_dwordx4 v17, s[16:19], s58 offen offset:3072 sc1 lds
    v_mfma_f32_16x16x32_bf16 v[152:155], v[32:35], v[160:163], v[152:155]
    ds_read_b64_tr_b16 v[54:55], v7 offset:5120
    v_mfma_f32_16x16x32_bf16 v[156:159], v[36:39], v[160:163], v[156:159]
    ds_read2st64_b64 v[60:63], v13 offset0:4 offset1:14
    s_cmp_ge_u32 s59, s56
    s_cbranch_scc1 parallel_sum__softmax_full_mha__glu_gated_swiglu__prompt_kernel_cb4
    s_barrier
    s_add_u32 s59, s59, 1
parallel_sum__softmax_full_mha__glu_gated_swiglu__prompt_kernel_cb4:
    s_waitcnt lgkmcnt(1)
    v_mfma_f32_16x16x32_bf16 v[64:67], v[40:43], v[56:59], v[64:67]
    ds_read2st64_b64 v[160:163], v15 offset0:6 offset1:16
    v_mfma_f32_16x16x32_bf16 v[68:71], v[44:47], v[56:59], v[68:71]
    s_add_u32 s58, s36, 8192
    s_add_u32 m0, s15, 22528
    s_nop 0
    buffer_load_dwordx4 v10, s[16:19], s58 offen offset:2048 sc1 lds
    v_mfma_f32_16x16x32_bf16 v[72:75], v[48:51], v[56:59], v[72:75]
    v_mfma_f32_16x16x32_bf16 v[76:79], v[52:55], v[56:59], v[76:79]
    s_add_u32 s58, s36, 8192
    s_add_u32 m0, s15, 26624
    s_nop 0
    buffer_load_dwordx4 v10, s[16:19], s58 offen offset:3072 sc1 lds
    s_waitcnt lgkmcnt(1)
    v_mfma_f32_16x16x32_bf16 v[80:83], v[40:43], v[60:63], v[80:83]
    ds_read2st64_b64 v[56:59], v13 offset0:6 offset1:16
    v_mfma_f32_16x16x32_bf16 v[84:87], v[44:47], v[60:63], v[84:87]
    s_add_u32 m0, s15, 0
    s_nop 0
    buffer_load_dwordx4 v8, s[48:51], s37 offen lds
    v_mfma_f32_16x16x32_bf16 v[88:91], v[48:51], v[60:63], v[88:91]
    v_mfma_f32_16x16x32_bf16 v[92:95], v[52:55], v[60:63], v[92:95]
    buffer_load_dwordx4 v9, s[48:51], s37 offen offset:1024 lds
    s_add_u32 s37, s37, 20480
    s_waitcnt lgkmcnt(1)
    v_mfma_f32_16x16x32_bf16 v[96:99], v[40:43], v[160:163], v[96:99]
    ds_read2st64_b64 v[60:63], v15 offset0:8 offset1:18
    v_mfma_f32_16x16x32_bf16 v[100:103], v[44:47], v[160:163], v[100:103]
    s_add_u32 m0, s15, 5120
    s_nop 0
    buffer_load_dwordx4 v8, s[48:51], s37 offen lds
    v_mfma_f32_16x16x32_bf16 v[104:107], v[48:51], v[160:163], v[104:107]
    v_mfma_f32_16x16x32_bf16 v[108:111], v[52:55], v[160:163], v[108:111]
    buffer_load_dwordx4 v9, s[48:51], s37 offen offset:1024 lds
    s_add_u32 s37, s37, 20480
    s_waitcnt lgkmcnt(1)
    v_mfma_f32_16x16x32_bf16 v[112:115], v[40:43], v[56:59], v[112:115]
    ds_read2st64_b64 v[160:163], v13 offset0:8 offset1:18
    v_mfma_f32_16x16x32_bf16 v[116:119], v[44:47], v[56:59], v[116:119]
    s_add_u32 s58, s36, 12288
    s_add_u32 m0, s15, 2048
    s_nop 0
    buffer_load_dwordx4 v2, s[16:19], s58 offen offset:0 sc1 lds
    v_mfma_f32_16x16x32_bf16 v[120:123], v[48:51], v[56:59], v[120:123]
    v_mfma_f32_16x16x32_bf16 v[124:127], v[52:55], v[56:59], v[124:127]
    s_add_u32 s58, s36, 12288
    s_add_u32 m0, s15, 6144
    s_nop 0
    buffer_load_dwordx4 v2, s[16:19], s58 offen offset:1024 sc1 lds
    s_waitcnt vmcnt(16)
    s_waitcnt lgkmcnt(1)
    v_mfma_f32_16x16x32_bf16 v[128:131], v[40:43], v[60:63], v[128:131]
    ds_read_b64_tr_b16 v[24:25], v16 offset:10240
    ds_read_b64_tr_b16 v[26:27], v16 offset:15360
    v_mfma_f32_16x16x32_bf16 v[132:135], v[44:47], v[60:63], v[132:135]
    ds_read_b64_tr_b16 v[28:29], v5 offset:10240
    s_add_u32 s58, s36, 12288
    s_add_u32 m0, s15, 3072
    s_nop 0
    buffer_load_dwordx4 v17, s[16:19], s58 offen offset:0 sc1 lds
    v_mfma_f32_16x16x32_bf16 v[136:139], v[48:51], v[60:63], v[136:139]
    ds_read_b64_tr_b16 v[30:31], v5 offset:15360
    v_mfma_f32_16x16x32_bf16 v[140:143], v[52:55], v[60:63], v[140:143]
    ds_read2st64_b64 v[56:59], v15 offset0:24 offset1:34
    s_waitcnt lgkmcnt(5)
    v_mfma_f32_16x16x32_bf16 v[144:147], v[40:43], v[160:163], v[144:147]
    ds_read_b64_tr_b16 v[32:33], v6 offset:10240
    ds_read_b64_tr_b16 v[34:35], v6 offset:15360
    v_mfma_f32_16x16x32_bf16 v[148:151], v[44:47], v[160:163], v[148:151]
    ds_read_b64_tr_b16 v[36:37], v7 offset:10240
    s_add_u32 s58, s36, 12288
    s_add_u32 m0, s15, 7168
    s_nop 0
    buffer_load_dwordx4 v17, s[16:19], s58 offen offset:1024 sc1 lds
    v_mfma_f32_16x16x32_bf16 v[152:155], v[48:51], v[160:163], v[152:155]
    ds_read_b64_tr_b16 v[38:39], v7 offset:15360
    v_mfma_f32_16x16x32_bf16 v[156:159], v[52:55], v[160:163], v[156:159]
    ds_read2st64_b64 v[60:63], v13 offset0:24 offset1:34
    s_cmp_ge_u32 s59, s56
    s_cbranch_scc1 parallel_sum__softmax_full_mha__glu_gated_swiglu__prompt_kernel_cb5
    s_barrier
    s_add_u32 s59, s59, 1
parallel_sum__softmax_full_mha__glu_gated_swiglu__prompt_kernel_cb5:
    s_waitcnt lgkmcnt(1)
    v_mfma_f32_16x16x32_bf16 v[64:67], v[24:27], v[56:59], v[64:67]
    ds_read2st64_b64 v[160:163], v15 offset0:26 offset1:36
    v_mfma_f32_16x16x32_bf16 v[68:71], v[28:31], v[56:59], v[68:71]
    s_add_u32 s58, s36, 12288
    s_add_u32 m0, s15, 4096
    s_nop 0
    buffer_load_dwordx4 v10, s[16:19], s58 offen offset:0 sc1 lds
    v_mfma_f32_16x16x32_bf16 v[72:75], v[32:35], v[56:59], v[72:75]
    v_mfma_f32_16x16x32_bf16 v[76:79], v[36:39], v[56:59], v[76:79]
    s_add_u32 s58, s36, 12288
    s_add_u32 m0, s15, 8192
    s_nop 0
    buffer_load_dwordx4 v10, s[16:19], s58 offen offset:1024 sc1 lds
    s_waitcnt lgkmcnt(1)
    v_mfma_f32_16x16x32_bf16 v[80:83], v[24:27], v[60:63], v[80:83]
    ds_read2st64_b64 v[56:59], v13 offset0:26 offset1:36
    v_mfma_f32_16x16x32_bf16 v[84:87], v[28:31], v[60:63], v[84:87]
    s_add_u32 m0, s15, 10240
    s_nop 0
    buffer_load_dwordx4 v8, s[48:51], s37 offen lds
    v_mfma_f32_16x16x32_bf16 v[88:91], v[32:35], v[60:63], v[88:91]
    v_mfma_f32_16x16x32_bf16 v[92:95], v[36:39], v[60:63], v[92:95]
    buffer_load_dwordx4 v9, s[48:51], s37 offen offset:1024 lds
    s_add_u32 s37, s37, 20480
    s_waitcnt lgkmcnt(1)
    v_mfma_f32_16x16x32_bf16 v[96:99], v[24:27], v[160:163], v[96:99]
    ds_read2st64_b64 v[60:63], v15 offset0:28 offset1:38
    v_mfma_f32_16x16x32_bf16 v[100:103], v[28:31], v[160:163], v[100:103]
    s_add_u32 m0, s15, 15360
    s_nop 0
    buffer_load_dwordx4 v8, s[48:51], s37 offen lds
    v_mfma_f32_16x16x32_bf16 v[104:107], v[32:35], v[160:163], v[104:107]
    v_mfma_f32_16x16x32_bf16 v[108:111], v[36:39], v[160:163], v[108:111]
    buffer_load_dwordx4 v9, s[48:51], s37 offen offset:1024 lds
    s_add_u32 s37, s37, 20480
    s_waitcnt lgkmcnt(1)
    v_mfma_f32_16x16x32_bf16 v[112:115], v[24:27], v[56:59], v[112:115]
    ds_read2st64_b64 v[160:163], v13 offset0:28 offset1:38
    v_mfma_f32_16x16x32_bf16 v[116:119], v[28:31], v[56:59], v[116:119]
    s_add_u32 s58, s36, 12288
    s_add_u32 m0, s15, 10240
    s_nop 0
    buffer_load_dwordx4 v2, s[16:19], s58 offen offset:2048 sc1 lds
    v_mfma_f32_16x16x32_bf16 v[120:123], v[32:35], v[56:59], v[120:123]
    v_mfma_f32_16x16x32_bf16 v[124:127], v[36:39], v[56:59], v[124:127]
    s_add_u32 s58, s36, 12288
    s_add_u32 m0, s15, 14336
    s_nop 0
    buffer_load_dwordx4 v2, s[16:19], s58 offen offset:3072 sc1 lds
    s_waitcnt vmcnt(16)
    s_waitcnt lgkmcnt(1)
    v_mfma_f32_16x16x32_bf16 v[128:131], v[24:27], v[60:63], v[128:131]
    ds_read_b64_tr_b16 v[40:41], v16 offset:20480
    ds_read_b64_tr_b16 v[42:43], v16 offset:25600
    v_mfma_f32_16x16x32_bf16 v[132:135], v[28:31], v[60:63], v[132:135]
    ds_read_b64_tr_b16 v[44:45], v5 offset:20480
    s_add_u32 s58, s36, 12288
    s_add_u32 m0, s15, 11264
    s_nop 0
    buffer_load_dwordx4 v17, s[16:19], s58 offen offset:2048 sc1 lds
    v_mfma_f32_16x16x32_bf16 v[136:139], v[32:35], v[60:63], v[136:139]
    ds_read_b64_tr_b16 v[46:47], v5 offset:25600
    v_mfma_f32_16x16x32_bf16 v[140:143], v[36:39], v[60:63], v[140:143]
    ds_read2st64_b64 v[56:59], v15 offset0:44 offset1:54
    s_waitcnt lgkmcnt(5)
    v_mfma_f32_16x16x32_bf16 v[144:147], v[24:27], v[160:163], v[144:147]
    ds_read_b64_tr_b16 v[48:49], v6 offset:20480
    ds_read_b64_tr_b16 v[50:51], v6 offset:25600
    v_mfma_f32_16x16x32_bf16 v[148:151], v[28:31], v[160:163], v[148:151]
    ds_read_b64_tr_b16 v[52:53], v7 offset:20480
    s_add_u32 s58, s36, 12288
    s_add_u32 m0, s15, 15360
    s_nop 0
    buffer_load_dwordx4 v17, s[16:19], s58 offen offset:3072 sc1 lds
    v_mfma_f32_16x16x32_bf16 v[152:155], v[32:35], v[160:163], v[152:155]
    ds_read_b64_tr_b16 v[54:55], v7 offset:25600
    v_mfma_f32_16x16x32_bf16 v[156:159], v[36:39], v[160:163], v[156:159]
    ds_read2st64_b64 v[60:63], v13 offset0:44 offset1:54
    s_cmp_ge_u32 s59, s56
    s_cbranch_scc1 parallel_sum__softmax_full_mha__glu_gated_swiglu__prompt_kernel_cb6
    s_barrier
    s_add_u32 s59, s59, 1
parallel_sum__softmax_full_mha__glu_gated_swiglu__prompt_kernel_cb6:
    s_waitcnt lgkmcnt(1)
    v_mfma_f32_16x16x32_bf16 v[64:67], v[40:43], v[56:59], v[64:67]
    ds_read2st64_b64 v[160:163], v15 offset0:46 offset1:56
    v_mfma_f32_16x16x32_bf16 v[68:71], v[44:47], v[56:59], v[68:71]
    s_add_u32 s58, s36, 12288
    s_add_u32 m0, s15, 12288
    s_nop 0
    buffer_load_dwordx4 v10, s[16:19], s58 offen offset:2048 sc1 lds
    v_mfma_f32_16x16x32_bf16 v[72:75], v[48:51], v[56:59], v[72:75]
    v_mfma_f32_16x16x32_bf16 v[76:79], v[52:55], v[56:59], v[76:79]
    s_add_u32 s58, s36, 12288
    s_add_u32 m0, s15, 16384
    s_nop 0
    buffer_load_dwordx4 v10, s[16:19], s58 offen offset:3072 sc1 lds
    s_waitcnt lgkmcnt(1)
    v_mfma_f32_16x16x32_bf16 v[80:83], v[40:43], v[60:63], v[80:83]
    ds_read2st64_b64 v[56:59], v13 offset0:46 offset1:56
    v_mfma_f32_16x16x32_bf16 v[84:87], v[44:47], v[60:63], v[84:87]
    s_add_u32 m0, s15, 20480
    s_nop 0
    buffer_load_dwordx4 v8, s[48:51], s37 offen lds
    v_mfma_f32_16x16x32_bf16 v[88:91], v[48:51], v[60:63], v[88:91]
    v_mfma_f32_16x16x32_bf16 v[92:95], v[52:55], v[60:63], v[92:95]
    buffer_load_dwordx4 v9, s[48:51], s37 offen offset:1024 lds
    s_add_u32 s37, s37, 20480
    s_waitcnt lgkmcnt(1)
    v_mfma_f32_16x16x32_bf16 v[96:99], v[40:43], v[160:163], v[96:99]
    ds_read2st64_b64 v[60:63], v15 offset0:48 offset1:58
    v_mfma_f32_16x16x32_bf16 v[100:103], v[44:47], v[160:163], v[100:103]
    s_add_u32 m0, s15, 25600
    s_nop 0
    buffer_load_dwordx4 v8, s[48:51], s37 offen lds
    v_mfma_f32_16x16x32_bf16 v[104:107], v[48:51], v[160:163], v[104:107]
    v_mfma_f32_16x16x32_bf16 v[108:111], v[52:55], v[160:163], v[108:111]
    buffer_load_dwordx4 v9, s[48:51], s37 offen offset:1024 lds
    s_add_u32 s37, s37, 20480
    s_waitcnt lgkmcnt(1)
    v_mfma_f32_16x16x32_bf16 v[112:115], v[40:43], v[56:59], v[112:115]
    ds_read2st64_b64 v[160:163], v13 offset0:48 offset1:58
    v_mfma_f32_16x16x32_bf16 v[116:119], v[44:47], v[56:59], v[116:119]
    s_add_u32 s58, s36, 16384
    s_add_u32 m0, s15, 22528
    s_nop 0
    buffer_load_dwordx4 v2, s[16:19], s58 offen offset:0 sc1 lds
    v_mfma_f32_16x16x32_bf16 v[120:123], v[48:51], v[56:59], v[120:123]
    v_mfma_f32_16x16x32_bf16 v[124:127], v[52:55], v[56:59], v[124:127]
    s_add_u32 s58, s36, 16384
    s_add_u32 m0, s15, 26624
    s_nop 0
    buffer_load_dwordx4 v2, s[16:19], s58 offen offset:1024 sc1 lds
    s_waitcnt vmcnt(16)
    s_waitcnt lgkmcnt(1)
    v_mfma_f32_16x16x32_bf16 v[128:131], v[40:43], v[60:63], v[128:131]
    ds_read_b64_tr_b16 v[24:25], v16 offset:0
    ds_read_b64_tr_b16 v[26:27], v16 offset:5120
    v_mfma_f32_16x16x32_bf16 v[132:135], v[44:47], v[60:63], v[132:135]
    ds_read_b64_tr_b16 v[28:29], v5 offset:0
    s_add_u32 s58, s36, 16384
    s_add_u32 m0, s15, 23552
    s_nop 0
    buffer_load_dwordx4 v17, s[16:19], s58 offen offset:0 sc1 lds
    v_mfma_f32_16x16x32_bf16 v[136:139], v[48:51], v[60:63], v[136:139]
    ds_read_b64_tr_b16 v[30:31], v5 offset:5120
    v_mfma_f32_16x16x32_bf16 v[140:143], v[52:55], v[60:63], v[140:143]
    ds_read2st64_b64 v[56:59], v15 offset0:4 offset1:14
    s_waitcnt lgkmcnt(5)
    v_mfma_f32_16x16x32_bf16 v[144:147], v[40:43], v[160:163], v[144:147]
    ds_read_b64_tr_b16 v[32:33], v6 offset:0
    ds_read_b64_tr_b16 v[34:35], v6 offset:5120
    v_mfma_f32_16x16x32_bf16 v[148:151], v[44:47], v[160:163], v[148:151]
    ds_read_b64_tr_b16 v[36:37], v7 offset:0
    s_add_u32 s58, s36, 16384
    s_add_u32 m0, s15, 27648
    s_nop 0
    buffer_load_dwordx4 v17, s[16:19], s58 offen offset:1024 sc1 lds
    v_mfma_f32_16x16x32_bf16 v[152:155], v[48:51], v[160:163], v[152:155]
    ds_read_b64_tr_b16 v[38:39], v7 offset:5120
    v_mfma_f32_16x16x32_bf16 v[156:159], v[52:55], v[160:163], v[156:159]
    ds_read2st64_b64 v[60:63], v13 offset0:4 offset1:14
    s_cmp_ge_u32 s59, s56
    s_cbranch_scc1 parallel_sum__softmax_full_mha__glu_gated_swiglu__prompt_kernel_cb7
    s_barrier
    s_add_u32 s59, s59, 1
parallel_sum__softmax_full_mha__glu_gated_swiglu__prompt_kernel_cb7:
    s_waitcnt lgkmcnt(1)
    v_mfma_f32_16x16x32_bf16 v[64:67], v[24:27], v[56:59], v[64:67]
    ds_read2st64_b64 v[160:163], v15 offset0:6 offset1:16
    v_mfma_f32_16x16x32_bf16 v[68:71], v[28:31], v[56:59], v[68:71]
    s_add_u32 s58, s36, 16384
    s_add_u32 m0, s15, 24576
    s_nop 0
    buffer_load_dwordx4 v10, s[16:19], s58 offen offset:0 sc1 lds
    v_mfma_f32_16x16x32_bf16 v[72:75], v[32:35], v[56:59], v[72:75]
    v_mfma_f32_16x16x32_bf16 v[76:79], v[36:39], v[56:59], v[76:79]
    s_add_u32 s58, s36, 16384
    s_add_u32 m0, s15, 28672
    s_nop 0
    buffer_load_dwordx4 v10, s[16:19], s58 offen offset:1024 sc1 lds
    s_waitcnt lgkmcnt(1)
    v_mfma_f32_16x16x32_bf16 v[80:83], v[24:27], v[60:63], v[80:83]
    ds_read2st64_b64 v[56:59], v13 offset0:6 offset1:16
    v_mfma_f32_16x16x32_bf16 v[84:87], v[28:31], v[60:63], v[84:87]
    s_add_u32 m0, s15, 0
    s_nop 0
    buffer_load_dwordx4 v8, s[48:51], s37 offen lds
    v_mfma_f32_16x16x32_bf16 v[88:91], v[32:35], v[60:63], v[88:91]
    v_mfma_f32_16x16x32_bf16 v[92:95], v[36:39], v[60:63], v[92:95]
    buffer_load_dwordx4 v9, s[48:51], s37 offen offset:1024 lds
    s_add_u32 s37, s37, 20480
    s_waitcnt lgkmcnt(1)
    v_mfma_f32_16x16x32_bf16 v[96:99], v[24:27], v[160:163], v[96:99]
    ds_read2st64_b64 v[60:63], v15 offset0:8 offset1:18
    v_mfma_f32_16x16x32_bf16 v[100:103], v[28:31], v[160:163], v[100:103]
    s_add_u32 m0, s15, 5120
    s_nop 0
    buffer_load_dwordx4 v8, s[48:51], s37 offen lds
    v_mfma_f32_16x16x32_bf16 v[104:107], v[32:35], v[160:163], v[104:107]
    v_mfma_f32_16x16x32_bf16 v[108:111], v[36:39], v[160:163], v[108:111]
    buffer_load_dwordx4 v9, s[48:51], s37 offen offset:1024 lds
    s_add_u32 s37, s37, 20480
    s_waitcnt lgkmcnt(1)
    v_mfma_f32_16x16x32_bf16 v[112:115], v[24:27], v[56:59], v[112:115]
    ds_read2st64_b64 v[160:163], v13 offset0:8 offset1:18
    v_mfma_f32_16x16x32_bf16 v[116:119], v[28:31], v[56:59], v[116:119]
    s_add_u32 s58, s36, 16384
    s_add_u32 m0, s15, 0
    s_nop 0
    buffer_load_dwordx4 v2, s[16:19], s58 offen offset:2048 sc1 lds
    v_mfma_f32_16x16x32_bf16 v[120:123], v[32:35], v[56:59], v[120:123]
    v_mfma_f32_16x16x32_bf16 v[124:127], v[36:39], v[56:59], v[124:127]
    s_add_u32 s58, s36, 16384
    s_add_u32 m0, s15, 4096
    s_nop 0
    buffer_load_dwordx4 v2, s[16:19], s58 offen offset:3072 sc1 lds
    s_waitcnt vmcnt(16)
    s_waitcnt lgkmcnt(1)
    v_mfma_f32_16x16x32_bf16 v[128:131], v[24:27], v[60:63], v[128:131]
    ds_read_b64_tr_b16 v[40:41], v16 offset:10240
    ds_read_b64_tr_b16 v[42:43], v16 offset:15360
    v_mfma_f32_16x16x32_bf16 v[132:135], v[28:31], v[60:63], v[132:135]
    ds_read_b64_tr_b16 v[44:45], v5 offset:10240
    s_add_u32 s58, s36, 16384
    s_add_u32 m0, s15, 1024
    s_nop 0
    buffer_load_dwordx4 v17, s[16:19], s58 offen offset:2048 sc1 lds
    v_mfma_f32_16x16x32_bf16 v[136:139], v[32:35], v[60:63], v[136:139]
    ds_read_b64_tr_b16 v[46:47], v5 offset:15360
    v_mfma_f32_16x16x32_bf16 v[140:143], v[36:39], v[60:63], v[140:143]
    ds_read2st64_b64 v[56:59], v15 offset0:24 offset1:34
    s_waitcnt lgkmcnt(5)
    v_mfma_f32_16x16x32_bf16 v[144:147], v[24:27], v[160:163], v[144:147]
    ds_read_b64_tr_b16 v[48:49], v6 offset:10240
    ds_read_b64_tr_b16 v[50:51], v6 offset:15360
    v_mfma_f32_16x16x32_bf16 v[148:151], v[28:31], v[160:163], v[148:151]
    ds_read_b64_tr_b16 v[52:53], v7 offset:10240
    s_add_u32 s58, s36, 16384
    s_add_u32 m0, s15, 5120
    s_nop 0
    buffer_load_dwordx4 v17, s[16:19], s58 offen offset:3072 sc1 lds
    v_mfma_f32_16x16x32_bf16 v[152:155], v[32:35], v[160:163], v[152:155]
    ds_read_b64_tr_b16 v[54:55], v7 offset:15360
    v_mfma_f32_16x16x32_bf16 v[156:159], v[36:39], v[160:163], v[156:159]
    ds_read2st64_b64 v[60:63], v13 offset0:24 offset1:34
    s_cmp_ge_u32 s59, s56
    s_cbranch_scc1 parallel_sum__softmax_full_mha__glu_gated_swiglu__prompt_kernel_cb8
    s_barrier
    s_add_u32 s59, s59, 1
parallel_sum__softmax_full_mha__glu_gated_swiglu__prompt_kernel_cb8:
    s_waitcnt lgkmcnt(1)
    v_mfma_f32_16x16x32_bf16 v[64:67], v[40:43], v[56:59], v[64:67]
    ds_read2st64_b64 v[160:163], v15 offset0:26 offset1:36
    v_mfma_f32_16x16x32_bf16 v[68:71], v[44:47], v[56:59], v[68:71]
    s_add_u32 s58, s36, 16384
    s_add_u32 m0, s15, 2048
    s_nop 0
    buffer_load_dwordx4 v10, s[16:19], s58 offen offset:2048 sc1 lds
    v_mfma_f32_16x16x32_bf16 v[72:75], v[48:51], v[56:59], v[72:75]
    v_mfma_f32_16x16x32_bf16 v[76:79], v[52:55], v[56:59], v[76:79]
    s_add_u32 s58, s36, 16384
    s_add_u32 m0, s15, 6144
    s_nop 0
    buffer_load_dwordx4 v10, s[16:19], s58 offen offset:3072 sc1 lds
    s_waitcnt lgkmcnt(1)
    v_mfma_f32_16x16x32_bf16 v[80:83], v[40:43], v[60:63], v[80:83]
    ds_read2st64_b64 v[56:59], v13 offset0:26 offset1:36
    v_mfma_f32_16x16x32_bf16 v[84:87], v[44:47], v[60:63], v[84:87]
    s_add_u32 m0, s15, 10240
    s_nop 0
    buffer_load_dwordx4 v8, s[48:51], s37 offen lds
    v_mfma_f32_16x16x32_bf16 v[88:91], v[48:51], v[60:63], v[88:91]
    v_mfma_f32_16x16x32_bf16 v[92:95], v[52:55], v[60:63], v[92:95]
    buffer_load_dwordx4 v9, s[48:51], s37 offen offset:1024 lds
    s_add_u32 s37, s37, 20480
    s_waitcnt lgkmcnt(1)
    v_mfma_f32_16x16x32_bf16 v[96:99], v[40:43], v[160:163], v[96:99]
    ds_read2st64_b64 v[60:63], v15 offset0:28 offset1:38
    v_mfma_f32_16x16x32_bf16 v[100:103], v[44:47], v[160:163], v[100:103]
    s_add_u32 m0, s15, 15360
    s_nop 0
    buffer_load_dwordx4 v8, s[48:51], s37 offen lds
    v_mfma_f32_16x16x32_bf16 v[104:107], v[48:51], v[160:163], v[104:107]
    v_mfma_f32_16x16x32_bf16 v[108:111], v[52:55], v[160:163], v[108:111]
    buffer_load_dwordx4 v9, s[48:51], s37 offen offset:1024 lds
    s_add_u32 s37, s37, 20480
    s_waitcnt lgkmcnt(1)
    v_mfma_f32_16x16x32_bf16 v[112:115], v[40:43], v[56:59], v[112:115]
    ds_read2st64_b64 v[160:163], v13 offset0:28 offset1:38
    v_mfma_f32_16x16x32_bf16 v[116:119], v[44:47], v[56:59], v[116:119]
    s_add_u32 s58, s36, 20480
    s_add_u32 m0, s15, 12288
    s_nop 0
    buffer_load_dwordx4 v2, s[16:19], s58 offen offset:0 sc1 lds
    v_mfma_f32_16x16x32_bf16 v[120:123], v[48:51], v[56:59], v[120:123]
    v_mfma_f32_16x16x32_bf16 v[124:127], v[52:55], v[56:59], v[124:127]
    s_add_u32 s58, s36, 20480
    s_add_u32 m0, s15, 16384
    s_nop 0
    buffer_load_dwordx4 v2, s[16:19], s58 offen offset:1024 sc1 lds
    s_waitcnt vmcnt(16)
    s_waitcnt lgkmcnt(1)
    v_mfma_f32_16x16x32_bf16 v[128:131], v[40:43], v[60:63], v[128:131]
    ds_read_b64_tr_b16 v[24:25], v16 offset:20480
    ds_read_b64_tr_b16 v[26:27], v16 offset:25600
    v_mfma_f32_16x16x32_bf16 v[132:135], v[44:47], v[60:63], v[132:135]
    ds_read_b64_tr_b16 v[28:29], v5 offset:20480
    s_add_u32 s58, s36, 20480
    s_add_u32 m0, s15, 13312
    s_nop 0
    buffer_load_dwordx4 v17, s[16:19], s58 offen offset:0 sc1 lds
    v_mfma_f32_16x16x32_bf16 v[136:139], v[48:51], v[60:63], v[136:139]
    ds_read_b64_tr_b16 v[30:31], v5 offset:25600
    v_mfma_f32_16x16x32_bf16 v[140:143], v[52:55], v[60:63], v[140:143]
    ds_read2st64_b64 v[56:59], v15 offset0:44 offset1:54
    s_waitcnt lgkmcnt(5)
    v_mfma_f32_16x16x32_bf16 v[144:147], v[40:43], v[160:163], v[144:147]
    ds_read_b64_tr_b16 v[32:33], v6 offset:20480
    ds_read_b64_tr_b16 v[34:35], v6 offset:25600
    v_mfma_f32_16x16x32_bf16 v[148:151], v[44:47], v[160:163], v[148:151]
    ds_read_b64_tr_b16 v[36:37], v7 offset:20480
    s_add_u32 s58, s36, 20480
    s_add_u32 m0, s15, 17408
    s_nop 0
    buffer_load_dwordx4 v17, s[16:19], s58 offen offset:1024 sc1 lds
    v_mfma_f32_16x16x32_bf16 v[152:155], v[48:51], v[160:163], v[152:155]
    ds_read_b64_tr_b16 v[38:39], v7 offset:25600
    v_mfma_f32_16x16x32_bf16 v[156:159], v[52:55], v[160:163], v[156:159]
    ds_read2st64_b64 v[60:63], v13 offset0:44 offset1:54
    s_cmp_ge_u32 s59, s56
    s_cbranch_scc1 parallel_sum__softmax_full_mha__glu_gated_swiglu__prompt_kernel_cb9
    s_barrier
    s_add_u32 s59, s59, 1
parallel_sum__softmax_full_mha__glu_gated_swiglu__prompt_kernel_cb9:
    s_waitcnt lgkmcnt(1)
    v_mfma_f32_16x16x32_bf16 v[64:67], v[24:27], v[56:59], v[64:67]
    ds_read2st64_b64 v[160:163], v15 offset0:46 offset1:56
    v_mfma_f32_16x16x32_bf16 v[68:71], v[28:31], v[56:59], v[68:71]
    s_add_u32 s58, s36, 20480
    s_add_u32 m0, s15, 14336
    s_nop 0
    buffer_load_dwordx4 v10, s[16:19], s58 offen offset:0 sc1 lds
    v_mfma_f32_16x16x32_bf16 v[72:75], v[32:35], v[56:59], v[72:75]
    v_mfma_f32_16x16x32_bf16 v[76:79], v[36:39], v[56:59], v[76:79]
    s_add_u32 s58, s36, 20480
    s_add_u32 m0, s15, 18432
    s_nop 0
    buffer_load_dwordx4 v10, s[16:19], s58 offen offset:1024 sc1 lds
    s_waitcnt lgkmcnt(1)
    v_mfma_f32_16x16x32_bf16 v[80:83], v[24:27], v[60:63], v[80:83]
    ds_read2st64_b64 v[56:59], v13 offset0:46 offset1:56
    v_mfma_f32_16x16x32_bf16 v[84:87], v[28:31], v[60:63], v[84:87]
    s_add_u32 m0, s15, 20480
    s_nop 0
    buffer_load_dwordx4 v8, s[48:51], s37 offen lds
    v_mfma_f32_16x16x32_bf16 v[88:91], v[32:35], v[60:63], v[88:91]
    v_mfma_f32_16x16x32_bf16 v[92:95], v[36:39], v[60:63], v[92:95]
    buffer_load_dwordx4 v9, s[48:51], s37 offen offset:1024 lds
    s_add_u32 s37, s37, 20480
    s_waitcnt lgkmcnt(1)
    v_mfma_f32_16x16x32_bf16 v[96:99], v[24:27], v[160:163], v[96:99]
    ds_read2st64_b64 v[60:63], v15 offset0:48 offset1:58
    v_mfma_f32_16x16x32_bf16 v[100:103], v[28:31], v[160:163], v[100:103]
    s_add_u32 m0, s15, 25600
    s_nop 0
    buffer_load_dwordx4 v8, s[48:51], s37 offen lds
    v_mfma_f32_16x16x32_bf16 v[104:107], v[32:35], v[160:163], v[104:107]
    v_mfma_f32_16x16x32_bf16 v[108:111], v[36:39], v[160:163], v[108:111]
    buffer_load_dwordx4 v9, s[48:51], s37 offen offset:1024 lds
    s_add_u32 s37, s37, 20480
    s_waitcnt lgkmcnt(1)
    v_mfma_f32_16x16x32_bf16 v[112:115], v[24:27], v[56:59], v[112:115]
    ds_read2st64_b64 v[160:163], v13 offset0:48 offset1:58
    v_mfma_f32_16x16x32_bf16 v[116:119], v[28:31], v[56:59], v[116:119]
    s_add_u32 s58, s36, 20480
    s_add_u32 m0, s15, 20480
    s_nop 0
    buffer_load_dwordx4 v2, s[16:19], s58 offen offset:2048 sc1 lds
    v_mfma_f32_16x16x32_bf16 v[120:123], v[32:35], v[56:59], v[120:123]
    v_mfma_f32_16x16x32_bf16 v[124:127], v[36:39], v[56:59], v[124:127]
    s_add_u32 s58, s36, 20480
    s_add_u32 m0, s15, 24576
    s_nop 0
    buffer_load_dwordx4 v2, s[16:19], s58 offen offset:3072 sc1 lds
    s_waitcnt vmcnt(16)
    s_waitcnt lgkmcnt(1)
    v_mfma_f32_16x16x32_bf16 v[128:131], v[24:27], v[60:63], v[128:131]
    ds_read_b64_tr_b16 v[40:41], v16 offset:0
    ds_read_b64_tr_b16 v[42:43], v16 offset:5120
    v_mfma_f32_16x16x32_bf16 v[132:135], v[28:31], v[60:63], v[132:135]
    ds_read_b64_tr_b16 v[44:45], v5 offset:0
    s_add_u32 s58, s36, 20480
    s_add_u32 m0, s15, 21504
    s_nop 0
    buffer_load_dwordx4 v17, s[16:19], s58 offen offset:2048 sc1 lds
    v_mfma_f32_16x16x32_bf16 v[136:139], v[32:35], v[60:63], v[136:139]
    ds_read_b64_tr_b16 v[46:47], v5 offset:5120
    v_mfma_f32_16x16x32_bf16 v[140:143], v[36:39], v[60:63], v[140:143]
    ds_read2st64_b64 v[56:59], v15 offset0:4 offset1:14
    s_waitcnt lgkmcnt(5)
    v_mfma_f32_16x16x32_bf16 v[144:147], v[24:27], v[160:163], v[144:147]
    ds_read_b64_tr_b16 v[48:49], v6 offset:0
    ds_read_b64_tr_b16 v[50:51], v6 offset:5120
    v_mfma_f32_16x16x32_bf16 v[148:151], v[28:31], v[160:163], v[148:151]
    ds_read_b64_tr_b16 v[52:53], v7 offset:0
    s_add_u32 s58, s36, 20480
    s_add_u32 m0, s15, 25600
    s_nop 0
    buffer_load_dwordx4 v17, s[16:19], s58 offen offset:3072 sc1 lds
    v_mfma_f32_16x16x32_bf16 v[152:155], v[32:35], v[160:163], v[152:155]
    ds_read_b64_tr_b16 v[54:55], v7 offset:5120
    v_mfma_f32_16x16x32_bf16 v[156:159], v[36:39], v[160:163], v[156:159]
    ds_read2st64_b64 v[60:63], v13 offset0:4 offset1:14
    s_cmp_ge_u32 s59, s56
    s_cbranch_scc1 parallel_sum__softmax_full_mha__glu_gated_swiglu__prompt_kernel_cb10
    s_barrier
    s_add_u32 s59, s59, 1
parallel_sum__softmax_full_mha__glu_gated_swiglu__prompt_kernel_cb10:
    s_waitcnt lgkmcnt(1)
    v_mfma_f32_16x16x32_bf16 v[64:67], v[40:43], v[56:59], v[64:67]
    ds_read2st64_b64 v[160:163], v15 offset0:6 offset1:16
    v_mfma_f32_16x16x32_bf16 v[68:71], v[44:47], v[56:59], v[68:71]
    s_add_u32 s58, s36, 20480
    s_add_u32 m0, s15, 22528
    s_nop 0
    buffer_load_dwordx4 v10, s[16:19], s58 offen offset:2048 sc1 lds
    v_mfma_f32_16x16x32_bf16 v[72:75], v[48:51], v[56:59], v[72:75]
    v_mfma_f32_16x16x32_bf16 v[76:79], v[52:55], v[56:59], v[76:79]
    s_add_u32 s58, s36, 20480
    s_add_u32 m0, s15, 26624
    s_nop 0
    buffer_load_dwordx4 v10, s[16:19], s58 offen offset:3072 sc1 lds
    s_waitcnt lgkmcnt(1)
    v_mfma_f32_16x16x32_bf16 v[80:83], v[40:43], v[60:63], v[80:83]
    ds_read2st64_b64 v[56:59], v13 offset0:6 offset1:16
    v_mfma_f32_16x16x32_bf16 v[84:87], v[44:47], v[60:63], v[84:87]
    s_add_u32 s58, s38, 0
    s_add_u32 m0, s15, 0
    s_nop 0
    buffer_load_dwordx4 v8, s[44:47], s58 offen offset:0 lds
    v_mfma_f32_16x16x32_bf16 v[88:91], v[48:51], v[60:63], v[88:91]
    v_mfma_f32_16x16x32_bf16 v[92:95], v[52:55], v[60:63], v[92:95]
    s_add_u32 s58, s38, 0
    s_add_u32 m0, s15, 0
    s_nop 0
    buffer_load_dwordx4 v9, s[44:47], s58 offen offset:1024 lds
    s_waitcnt lgkmcnt(1)
    v_mfma_f32_16x16x32_bf16 v[96:99], v[40:43], v[160:163], v[96:99]
    ds_read2st64_b64 v[60:63], v15 offset0:8 offset1:18
    v_mfma_f32_16x16x32_bf16 v[100:103], v[44:47], v[160:163], v[100:103]
    s_add_u32 s58, s38, 40960
    s_add_u32 m0, s15, 4096
    s_nop 0
    buffer_load_dwordx4 v9, s[44:47], s58 offen offset:1024 lds
    v_mfma_f32_16x16x32_bf16 v[104:107], v[48:51], v[160:163], v[104:107]
    v_mfma_f32_16x16x32_bf16 v[108:111], v[52:55], v[160:163], v[108:111]
    s_add_u32 s58, s38, 61440
    s_add_u32 m0, s15, 6144
    s_nop 0
    buffer_load_dwordx4 v8, s[44:47], s58 offen offset:0 lds
    s_waitcnt lgkmcnt(1)
    v_mfma_f32_16x16x32_bf16 v[112:115], v[40:43], v[56:59], v[112:115]
    ds_read2st64_b64 v[160:163], v13 offset0:8 offset1:18
    v_mfma_f32_16x16x32_bf16 v[116:119], v[44:47], v[56:59], v[116:119]
    s_add_u32 s58, s38, 20480
    s_add_u32 m0, s15, 2048
    s_nop 0
    buffer_load_dwordx4 v8, s[44:47], s58 offen offset:0 lds
    v_mfma_f32_16x16x32_bf16 v[120:123], v[48:51], v[56:59], v[120:123]
    v_mfma_f32_16x16x32_bf16 v[124:127], v[52:55], v[56:59], v[124:127]
    s_add_u32 s58, s38, 61440
    s_add_u32 m0, s15, 6144
    s_nop 0
    buffer_load_dwordx4 v9, s[44:47], s58 offen offset:1024 lds
    s_waitcnt vmcnt(16)
    s_waitcnt lgkmcnt(1)
    v_mfma_f32_16x16x32_bf16 v[128:131], v[40:43], v[60:63], v[128:131]
    ds_read_b64_tr_b16 v[24:25], v16 offset:10240
    ds_read_b64_tr_b16 v[26:27], v16 offset:15360
    v_mfma_f32_16x16x32_bf16 v[132:135], v[44:47], v[60:63], v[132:135]
    ds_read_b64_tr_b16 v[28:29], v5 offset:10240
    s_add_u32 s58, s38, 20480
    s_add_u32 m0, s15, 2048
    s_nop 0
    buffer_load_dwordx4 v9, s[44:47], s58 offen offset:1024 lds
    v_mfma_f32_16x16x32_bf16 v[136:139], v[48:51], v[60:63], v[136:139]
    ds_read_b64_tr_b16 v[30:31], v5 offset:15360
    v_mfma_f32_16x16x32_bf16 v[140:143], v[52:55], v[60:63], v[140:143]
    ds_read2st64_b64 v[56:59], v15 offset0:24 offset1:34
    s_waitcnt lgkmcnt(5)
    v_mfma_f32_16x16x32_bf16 v[144:147], v[40:43], v[160:163], v[144:147]
    ds_read_b64_tr_b16 v[32:33], v6 offset:10240
    ds_read_b64_tr_b16 v[34:35], v6 offset:15360
    v_mfma_f32_16x16x32_bf16 v[148:151], v[44:47], v[160:163], v[148:151]
    ds_read_b64_tr_b16 v[36:37], v7 offset:10240
    s_add_u32 s58, s38, 81920
    s_add_u32 m0, s15, 8192
    s_nop 0
    buffer_load_dwordx4 v8, s[44:47], s58 offen offset:0 lds
    v_mfma_f32_16x16x32_bf16 v[152:155], v[48:51], v[160:163], v[152:155]
    ds_read_b64_tr_b16 v[38:39], v7 offset:15360
    v_mfma_f32_16x16x32_bf16 v[156:159], v[52:55], v[160:163], v[156:159]
    ds_read2st64_b64 v[60:63], v13 offset0:24 offset1:34
    s_cmp_ge_u32 s59, s56
    s_cbranch_scc1 parallel_sum__softmax_full_mha__glu_gated_swiglu__prompt_kernel_cb11
    s_barrier
    s_add_u32 s59, s59, 1
parallel_sum__softmax_full_mha__glu_gated_swiglu__prompt_kernel_cb11:
    s_waitcnt lgkmcnt(1)
    v_mfma_f32_16x16x32_bf16 v[64:67], v[24:27], v[56:59], v[64:67]
    ds_read2st64_b64 v[160:163], v15 offset0:26 offset1:36
    v_mfma_f32_16x16x32_bf16 v[68:71], v[28:31], v[56:59], v[68:71]
    s_add_u32 s58, s38, 40960
    s_add_u32 m0, s15, 4096
    s_nop 0
    buffer_load_dwordx4 v8, s[44:47], s58 offen offset:0 lds
    v_mfma_f32_16x16x32_bf16 v[72:75], v[32:35], v[56:59], v[72:75]
    v_mfma_f32_16x16x32_bf16 v[76:79], v[36:39], v[56:59], v[76:79]
    s_add_u32 s58, s38, 81920
    s_add_u32 m0, s15, 8192
    s_nop 0
    buffer_load_dwordx4 v9, s[44:47], s58 offen offset:1024 lds
    s_waitcnt lgkmcnt(1)
    v_mfma_f32_16x16x32_bf16 v[80:83], v[24:27], v[60:63], v[80:83]
    ds_read2st64_b64 v[56:59], v13 offset0:26 offset1:36
    v_mfma_f32_16x16x32_bf16 v[84:87], v[28:31], v[60:63], v[84:87]
    s_add_u32 s58, s38, 102400
    s_add_u32 m0, s15, 10240
    s_nop 0
    buffer_load_dwordx4 v8, s[44:47], s58 offen offset:0 lds
    v_mfma_f32_16x16x32_bf16 v[88:91], v[32:35], v[60:63], v[88:91]
    v_mfma_f32_16x16x32_bf16 v[92:95], v[36:39], v[60:63], v[92:95]
    s_add_u32 s58, s38, 102400
    s_add_u32 m0, s15, 10240
    s_nop 0
    buffer_load_dwordx4 v9, s[44:47], s58 offen offset:1024 lds
    s_waitcnt lgkmcnt(1)
    v_mfma_f32_16x16x32_bf16 v[96:99], v[24:27], v[160:163], v[96:99]
    ds_read2st64_b64 v[60:63], v15 offset0:28 offset1:38
    v_mfma_f32_16x16x32_bf16 v[100:103], v[28:31], v[160:163], v[100:103]
    s_add_u32 s58, s38, 143360
    s_add_u32 m0, s15, 14336
    s_nop 0
    buffer_load_dwordx4 v9, s[44:47], s58 offen offset:1024 lds
    v_mfma_f32_16x16x32_bf16 v[104:107], v[32:35], v[160:163], v[104:107]
    v_mfma_f32_16x16x32_bf16 v[108:111], v[36:39], v[160:163], v[108:111]
    s_add_u32 s58, s38, 163840
    s_add_u32 m0, s15, 16384
    s_nop 0
    buffer_load_dwordx4 v8, s[44:47], s58 offen offset:0 lds
    s_waitcnt lgkmcnt(1)
    v_mfma_f32_16x16x32_bf16 v[112:115], v[24:27], v[56:59], v[112:115]
    ds_read2st64_b64 v[160:163], v13 offset0:28 offset1:38
    v_mfma_f32_16x16x32_bf16 v[116:119], v[28:31], v[56:59], v[116:119]
    s_add_u32 s58, s38, 122880
    s_add_u32 m0, s15, 12288
    s_nop 0
    buffer_load_dwordx4 v8, s[44:47], s58 offen offset:0 lds
    v_mfma_f32_16x16x32_bf16 v[120:123], v[32:35], v[56:59], v[120:123]
    v_mfma_f32_16x16x32_bf16 v[124:127], v[36:39], v[56:59], v[124:127]
    s_add_u32 s58, s38, 163840
    s_add_u32 m0, s15, 16384
    s_nop 0
    buffer_load_dwordx4 v9, s[44:47], s58 offen offset:1024 lds
    s_waitcnt vmcnt(16)
    s_waitcnt lgkmcnt(1)
    v_mfma_f32_16x16x32_bf16 v[128:131], v[24:27], v[60:63], v[128:131]
    ds_read_b64_tr_b16 v[40:41], v16 offset:20480
    ds_read_b64_tr_b16 v[42:43], v16 offset:25600
    v_mfma_f32_16x16x32_bf16 v[132:135], v[28:31], v[60:63], v[132:135]
    ds_read_b64_tr_b16 v[44:45], v5 offset:20480
    s_add_u32 s58, s38, 122880
    s_add_u32 m0, s15, 12288
    s_nop 0
    buffer_load_dwordx4 v9, s[44:47], s58 offen offset:1024 lds
    v_mfma_f32_16x16x32_bf16 v[136:139], v[32:35], v[60:63], v[136:139]
    ds_read_b64_tr_b16 v[46:47], v5 offset:25600
    v_mfma_f32_16x16x32_bf16 v[140:143], v[36:39], v[60:63], v[140:143]
    ds_read2st64_b64 v[56:59], v15 offset0:44 offset1:54
    s_waitcnt lgkmcnt(5)
    v_mfma_f32_16x16x32_bf16 v[144:147], v[24:27], v[160:163], v[144:147]
    ds_read_b64_tr_b16 v[48:49], v6 offset:20480
    ds_read_b64_tr_b16 v[50:51], v6 offset:25600
    v_mfma_f32_16x16x32_bf16 v[148:151], v[28:31], v[160:163], v[148:151]
    ds_read_b64_tr_b16 v[52:53], v7 offset:20480
    s_add_u32 s58, s38, 184320
    s_add_u32 m0, s15, 18432
    s_nop 0
    buffer_load_dwordx4 v8, s[44:47], s58 offen offset:0 lds
    v_mfma_f32_16x16x32_bf16 v[152:155], v[32:35], v[160:163], v[152:155]
    ds_read_b64_tr_b16 v[54:55], v7 offset:25600
    v_mfma_f32_16x16x32_bf16 v[156:159], v[36:39], v[160:163], v[156:159]
    ds_read2st64_b64 v[60:63], v13 offset0:44 offset1:54
    s_cmp_ge_u32 s59, s56
    s_cbranch_scc1 parallel_sum__softmax_full_mha__glu_gated_swiglu__prompt_kernel_cb12
    s_barrier
    s_add_u32 s59, s59, 1
parallel_sum__softmax_full_mha__glu_gated_swiglu__prompt_kernel_cb12:
    buffer_load_dword v12, v11, s[16:19], s39 offen sc1
    v_readfirstlane_b32 s57, v18
    v_lshrrev_b32 v164, 1, v1
    v_and_b32 v165, 1, v1
    v_lshlrev_b32 v5, 4, v4
    v_lshl_add_u32 v5, v165, 9, v5
    v_lshl_add_u32 v5, v164, 10, v5
    v_lshlrev_b32 v6, 3, v4
    v_lshl_add_u32 v6, v1, 9, v6
    v_lshrrev_b32 v3, 3, v0
    v_mul_u32_u24 v3, 1280, v3
    v_and_b32 v7, 7, v0
    v_lshl_add_u32 v3, v7, 4, v3
    s_mul_i32 s3, s24, 10240
    v_add_u32 v3, s3, v3
    v_mul_u32_u24 v7, 1536, v164
    v_add_u32 v7, v7, v16
    v_lshlrev_b32 v164, 6, v164
    v_xor_b32 v7, v7, v164
    s_lshl_b32 s28, s6, 5
    s_lshl_b32 s3, s24, 3
    s_add_u32 s28, s28, s3
    s_lshl_b32 s34, s28, 8
    s_add_u32 s34, s34, 18874368
    s_add_u32 s35, s34, 8192
    s_add_u32 s36, s34, 16384
    s_add_u32 s36, s36, s27
    s_lshl_b32 s28, s28, 10
    s_add_u32 s28, s28, 16777216
    s_add_u32 s29, s28, 32768
    s_add_u32 s30, s28, 65536
    s_add_u32 s30, s30, s27
    s_add_u32 s31, s28, 4096
    s_add_u32 s32, s29, 4096
    s_add_u32 s33, s30, 4096
    s_mul_i32 s20, s6, 40960
    s_lshl_b32 s3, s7, 7
    s_add_u32 s20, s20, s3
    s_add_u32 s21, s20, 40960
    s_add_u32 s22, s20, 81920
    s_add_u32 s22, s22, s27
    s_mov_b32 s40, s92
    s_and_b32 s41, s93, 0xffff
    s_mov_b32 s42, 2621440
    s_mov_b32 s43, 0x00020000
    s_mov_b32 s48, s96
    s_and_b32 s49, s97, 0xffff
    s_mov_b32 s50, 2621440
    s_mov_b32 s51, 0x00020000
    s_waitcnt lgkmcnt(1)
    v_mfma_f32_16x16x32_bf16 v[64:67], v[40:43], v[56:59], v[64:67]
    ds_read2st64_b64 v[160:163], v15 offset0:46 offset1:56
    v_mfma_f32_16x16x32_bf16 v[68:71], v[44:47], v[56:59], v[68:71]
    s_add_u32 s58, s38, 143360
    s_add_u32 m0, s15, 14336
    s_nop 0
    buffer_load_dwordx4 v8, s[44:47], s58 offen offset:0 lds
    v_mfma_f32_16x16x32_bf16 v[72:75], v[48:51], v[56:59], v[72:75]
    v_mfma_f32_16x16x32_bf16 v[76:79], v[52:55], v[56:59], v[76:79]
    s_add_u32 s58, s38, 184320
    s_add_u32 m0, s15, 18432
    s_nop 0
    buffer_load_dwordx4 v9, s[44:47], s58 offen offset:1024 lds
    s_waitcnt lgkmcnt(1)
    v_mfma_f32_16x16x32_bf16 v[80:83], v[40:43], v[60:63], v[80:83]
    ds_read2st64_b64 v[56:59], v13 offset0:46 offset1:56
    v_mfma_f32_16x16x32_bf16 v[84:87], v[44:47], v[60:63], v[84:87]
    v_mfma_f32_16x16x32_bf16 v[88:91], v[48:51], v[60:63], v[88:91]
    v_mfma_f32_16x16x32_bf16 v[92:95], v[52:55], v[60:63], v[92:95]
    s_waitcnt lgkmcnt(1)
    v_mfma_f32_16x16x32_bf16 v[96:99], v[40:43], v[160:163], v[96:99]
    ds_read2st64_b64 v[60:63], v15 offset0:48 offset1:58
    v_mfma_f32_16x16x32_bf16 v[100:103], v[44:47], v[160:163], v[100:103]
    v_mfma_f32_16x16x32_bf16 v[104:107], v[48:51], v[160:163], v[104:107]
    v_mfma_f32_16x16x32_bf16 v[108:111], v[52:55], v[160:163], v[108:111]
    s_waitcnt lgkmcnt(1)
    v_mfma_f32_16x16x32_bf16 v[112:115], v[40:43], v[56:59], v[112:115]
    ds_read2st64_b64 v[160:163], v13 offset0:48 offset1:58
    v_mfma_f32_16x16x32_bf16 v[116:119], v[44:47], v[56:59], v[116:119]
    v_mfma_f32_16x16x32_bf16 v[120:123], v[48:51], v[56:59], v[120:123]
    v_mfma_f32_16x16x32_bf16 v[124:127], v[52:55], v[56:59], v[124:127]
    s_waitcnt lgkmcnt(1)
    v_mfma_f32_16x16x32_bf16 v[128:131], v[40:43], v[60:63], v[128:131]
    v_mfma_f32_16x16x32_bf16 v[132:135], v[44:47], v[60:63], v[132:135]
    v_mfma_f32_16x16x32_bf16 v[136:139], v[48:51], v[60:63], v[136:139]
    v_mfma_f32_16x16x32_bf16 v[140:143], v[52:55], v[60:63], v[140:143]
    s_waitcnt lgkmcnt(0)
    v_mfma_f32_16x16x32_bf16 v[144:147], v[40:43], v[160:163], v[144:147]
    v_mfma_f32_16x16x32_bf16 v[148:151], v[44:47], v[160:163], v[148:151]
    v_mfma_f32_16x16x32_bf16 v[152:155], v[48:51], v[160:163], v[152:155]
    v_mfma_f32_16x16x32_bf16 v[156:159], v[52:55], v[160:163], v[156:159]
    s_cmp_ge_u32 s59, s56
    s_cbranch_scc1 parallel_sum__softmax_full_mha__glu_gated_swiglu__prompt_kernel_cb13
    s_barrier
    s_add_u32 s59, s59, 1
parallel_sum__softmax_full_mha__glu_gated_swiglu__prompt_kernel_cb13:
    s_setprio 1
parallel_sum__softmax_full_mha__glu_gated_swiglu__prompt_kernel_drain:
    s_cmp_ge_u32 s59, 16
    s_cbranch_scc1 parallel_sum__softmax_full_mha__glu_gated_swiglu__prompt_kernel_drained
    s_barrier
    s_add_u32 s59, s59, 1
    s_branch parallel_sum__softmax_full_mha__glu_gated_swiglu__prompt_kernel_drain
parallel_sum__softmax_full_mha__glu_gated_swiglu__prompt_kernel_drained:
    s_waitcnt vmcnt(2)
    s_mov_b32 s13, 0x100000
    s_branch parallel_sum__softmax_full_mha__glu_gated_swiglu__prompt_kernel_op_t
    s_mov_b32 s13, 0x100000
parallel_sum__softmax_full_mha__glu_gated_swiglu__prompt_kernel_op_l:
    buffer_load_dword v12, v11, s[16:19], s39 offen sc1
    s_sub_u32 s13, s13, 1
    s_cmp_eq_u32 s13, 0
    s_cselect_b32 s99, 0, s99
    v_mov_b32 v14, 155892
    ds_read_b32 v13, v14
    s_waitcnt lgkmcnt(0)
    v_cmp_lt_u32 vcc, s59, v13
    s_cbranch_vccz parallel_sum__softmax_full_mha__glu_gated_swiglu__prompt_kernel_op_j
    s_barrier
    s_add_u32 s59, s59, 1
parallel_sum__softmax_full_mha__glu_gated_swiglu__prompt_kernel_op_j:
    s_waitcnt vmcnt(0)
parallel_sum__softmax_full_mha__glu_gated_swiglu__prompt_kernel_op_t:
    v_cmp_ne_u32 vcc, s99, v12
    s_cmp_eq_u32 s99, 0
    s_cselect_b32 s3, 0, vcc_lo
    s_and_b32 s58, s3, 0xff
    s_cbranch_scc0 parallel_sum__softmax_full_mha__glu_gated_swiglu__prompt_kernel_o_both
    s_sleep 1
    s_branch parallel_sum__softmax_full_mha__glu_gated_swiglu__prompt_kernel_op_l
parallel_sum__softmax_full_mha__glu_gated_swiglu__prompt_kernel_o_both:
    buffer_load_dwordx4 v[16:19], v5, s[16:19], s28 offen offset:0 sc1
    buffer_load_dwordx4 v[20:23], v5, s[16:19], s28 offen offset:256 sc1
    buffer_load_dwordx4 v[24:27], v5, s[16:19], s29 offen offset:0 sc1
    buffer_load_dwordx4 v[28:31], v5, s[16:19], s29 offen offset:256 sc1
    buffer_load_dwordx4 v[32:35], v5, s[16:19], s30 offen offset:0 sc1
    buffer_load_dwordx4 v[36:39], v5, s[16:19], s30 offen offset:256 sc1
parallel_sum__softmax_full_mha__glu_gated_swiglu__prompt_kernel_o_go:
    buffer_load_dwordx4 v[40:43], v5, s[16:19], s28 offen offset:2048 sc1
    buffer_load_dwordx4 v[44:47], v5, s[16:19], s28 offen offset:2304 sc1
    buffer_load_dwordx4 v[48:51], v5, s[16:19], s29 offen offset:2048 sc1
    buffer_load_dwordx4 v[52:55], v5, s[16:19], s29 offen offset:2304 sc1
    buffer_load_dwordx4 v[56:59], v5, s[16:19], s30 offen offset:2048 sc1
    buffer_load_dwordx4 v[60:63], v5, s[16:19], s30 offen offset:2304 sc1
    s_waitcnt vmcnt(12)
    v_mov_b32 v12, v7
    v_xor_b32 v13, 32, v7
    v_xor_b32 v14, 64, v7
    v_xor_b32 v15, 0x60, v7
    ds_read_b64_tr_b16 v[160:161], v12 offset:0
    ds_read_b64_tr_b16 v[162:163], v12 offset:1024
    ds_read_b64_tr_b16 v[164:165], v13 offset:0
    ds_read_b64_tr_b16 v[166:167], v13 offset:1024
    s_waitcnt vmcnt(6)
    s_waitcnt lgkmcnt(2)
    v_mfma_f32_16x16x32_bf16 v[64:67], v[160:163], v[16:19], v[64:67]
    ds_read_b64_tr_b16 v[8:9], v14 offset:0
    v_mfma_f32_16x16x32_bf16 v[80:83], v[160:163], v[20:23], v[80:83]
    ds_read_b64_tr_b16 v[10:11], v14 offset:1024
    v_mfma_f32_16x16x32_bf16 v[96:99], v[160:163], v[24:27], v[96:99]
    v_mfma_f32_16x16x32_bf16 v[112:115], v[160:163], v[28:31], v[112:115]
    v_mfma_f32_16x16x32_bf16 v[128:131], v[160:163], v[32:35], v[128:131]
    v_mfma_f32_16x16x32_bf16 v[144:147], v[160:163], v[36:39], v[144:147]
    s_waitcnt lgkmcnt(2)
    v_mfma_f32_16x16x32_bf16 v[68:71], v[164:167], v[16:19], v[68:71]
    ds_read_b64_tr_b16 v[160:161], v15 offset:0
    v_mfma_f32_16x16x32_bf16 v[84:87], v[164:167], v[20:23], v[84:87]
    ds_read_b64_tr_b16 v[162:163], v15 offset:1024
    v_mfma_f32_16x16x32_bf16 v[100:103], v[164:167], v[24:27], v[100:103]
    v_mfma_f32_16x16x32_bf16 v[116:119], v[164:167], v[28:31], v[116:119]
    v_mfma_f32_16x16x32_bf16 v[132:135], v[164:167], v[32:35], v[132:135]
    v_mfma_f32_16x16x32_bf16 v[148:151], v[164:167], v[36:39], v[148:151]
    s_waitcnt lgkmcnt(2)
    v_mfma_f32_16x16x32_bf16 v[72:75], v[8:11], v[16:19], v[72:75]
    ds_read_b64_tr_b16 v[164:165], v12 offset:5120
    v_mfma_f32_16x16x32_bf16 v[88:91], v[8:11], v[20:23], v[88:91]
    ds_read_b64_tr_b16 v[166:167], v12 offset:6144
    v_mfma_f32_16x16x32_bf16 v[104:107], v[8:11], v[24:27], v[104:107]
    v_mfma_f32_16x16x32_bf16 v[120:123], v[8:11], v[28:31], v[120:123]
    v_mfma_f32_16x16x32_bf16 v[136:139], v[8:11], v[32:35], v[136:139]
    v_mfma_f32_16x16x32_bf16 v[152:155], v[8:11], v[36:39], v[152:155]
    s_waitcnt lgkmcnt(2)
    v_mfma_f32_16x16x32_bf16 v[76:79], v[160:163], v[16:19], v[76:79]
    ds_read_b64_tr_b16 v[8:9], v13 offset:5120
    buffer_load_dwordx4 v[16:19], v5, s[16:19], s31 offen offset:0 sc1
    v_mfma_f32_16x16x32_bf16 v[92:95], v[160:163], v[20:23], v[92:95]
    ds_read_b64_tr_b16 v[10:11], v13 offset:6144
    buffer_load_dwordx4 v[20:23], v5, s[16:19], s31 offen offset:256 sc1
    v_mfma_f32_16x16x32_bf16 v[108:111], v[160:163], v[24:27], v[108:111]
    buffer_load_dwordx4 v[24:27], v5, s[16:19], s32 offen offset:0 sc1
    v_mfma_f32_16x16x32_bf16 v[124:127], v[160:163], v[28:31], v[124:127]
    buffer_load_dwordx4 v[28:31], v5, s[16:19], s32 offen offset:256 sc1
    v_mfma_f32_16x16x32_bf16 v[140:143], v[160:163], v[32:35], v[140:143]
    buffer_load_dwordx4 v[32:35], v5, s[16:19], s33 offen offset:0 sc1
    v_mfma_f32_16x16x32_bf16 v[156:159], v[160:163], v[36:39], v[156:159]
    buffer_load_dwordx4 v[36:39], v5, s[16:19], s33 offen offset:256 sc1
    s_waitcnt vmcnt(6)
    s_waitcnt lgkmcnt(2)
    v_mfma_f32_16x16x32_bf16 v[64:67], v[164:167], v[40:43], v[64:67]
    ds_read_b64_tr_b16 v[160:161], v14 offset:5120
    v_bfe_u32 v7, v0, 2, 2
    v_mad_u32_u24 v7, v1, 40, v7
    v_mfma_f32_16x16x32_bf16 v[80:83], v[164:167], v[44:47], v[80:83]
    ds_read_b64_tr_b16 v[162:163], v14 offset:6144
    v_lshlrev_b32 v7, 7, v7
    v_add_u32 v7, s15, v7
    v_mfma_f32_16x16x32_bf16 v[96:99], v[164:167], v[48:51], v[96:99]
    v_and_b32 v2, 3, v0
    v_lshl_add_u32 v7, v2, 3, v7
    v_mfma_f32_16x16x32_bf16 v[112:115], v[164:167], v[52:55], v[112:115]
    v_bfe_u32 v2, v0, 3, 1
    v_lshl_add_u32 v7, v2, 5, v7
    v_mfma_f32_16x16x32_bf16 v[128:131], v[164:167], v[56:59], v[128:131]
    v_mfma_f32_16x16x32_bf16 v[144:147], v[164:167], v[60:63], v[144:147]
    s_waitcnt lgkmcnt(2)
    v_mfma_f32_16x16x32_bf16 v[68:71], v[8:11], v[40:43], v[68:71]
    ds_read_b64_tr_b16 v[164:165], v15 offset:5120
    v_mfma_f32_16x16x32_bf16 v[84:87], v[8:11], v[44:47], v[84:87]
    ds_read_b64_tr_b16 v[166:167], v15 offset:6144
    v_mfma_f32_16x16x32_bf16 v[100:103], v[8:11], v[48:51], v[100:103]
    v_mfma_f32_16x16x32_bf16 v[116:119], v[8:11], v[52:55], v[116:119]
    v_mfma_f32_16x16x32_bf16 v[132:135], v[8:11], v[56:59], v[132:135]
    v_mfma_f32_16x16x32_bf16 v[148:151], v[8:11], v[60:63], v[148:151]
    s_waitcnt lgkmcnt(2)
    v_mfma_f32_16x16x32_bf16 v[72:75], v[160:163], v[40:43], v[72:75]
    ds_read_b64_tr_b16 v[8:9], v12 offset:10240
    v_mfma_f32_16x16x32_bf16 v[88:91], v[160:163], v[44:47], v[88:91]
    ds_read_b64_tr_b16 v[10:11], v12 offset:11264
    v_mfma_f32_16x16x32_bf16 v[104:107], v[160:163], v[48:51], v[104:107]
    v_mfma_f32_16x16x32_bf16 v[120:123], v[160:163], v[52:55], v[120:123]
    v_mfma_f32_16x16x32_bf16 v[136:139], v[160:163], v[56:59], v[136:139]
    v_mfma_f32_16x16x32_bf16 v[152:155], v[160:163], v[60:63], v[152:155]
    s_waitcnt lgkmcnt(2)
    v_mfma_f32_16x16x32_bf16 v[76:79], v[164:167], v[40:43], v[76:79]
    ds_read_b64_tr_b16 v[160:161], v13 offset:10240
    buffer_load_dwordx4 v[40:43], v5, s[16:19], s31 offen offset:2048 sc1
    v_mfma_f32_16x16x32_bf16 v[92:95], v[164:167], v[44:47], v[92:95]
    ds_read_b64_tr_b16 v[162:163], v13 offset:11264
    buffer_load_dwordx4 v[44:47], v5, s[16:19], s31 offen offset:2304 sc1
    v_mfma_f32_16x16x32_bf16 v[108:111], v[164:167], v[48:51], v[108:111]
    buffer_load_dwordx4 v[48:51], v5, s[16:19], s32 offen offset:2048 sc1
    v_mfma_f32_16x16x32_bf16 v[124:127], v[164:167], v[52:55], v[124:127]
    buffer_load_dwordx4 v[52:55], v5, s[16:19], s32 offen offset:2304 sc1
    v_mfma_f32_16x16x32_bf16 v[140:143], v[164:167], v[56:59], v[140:143]
    buffer_load_dwordx4 v[56:59], v5, s[16:19], s33 offen offset:2048 sc1
    v_mfma_f32_16x16x32_bf16 v[156:159], v[164:167], v[60:63], v[156:159]
    buffer_load_dwordx4 v[60:63], v5, s[16:19], s33 offen offset:2304 sc1
    s_waitcnt vmcnt(6)
    s_waitcnt lgkmcnt(2)
    v_mfma_f32_16x16x32_bf16 v[64:67], v[8:11], v[16:19], v[64:67]
    ds_read_b64_tr_b16 v[164:165], v14 offset:10240
    v_mfma_f32_16x16x32_bf16 v[80:83], v[8:11], v[20:23], v[80:83]
    ds_read_b64_tr_b16 v[166:167], v14 offset:11264
    v_mfma_f32_16x16x32_bf16 v[96:99], v[8:11], v[24:27], v[96:99]
    v_mfma_f32_16x16x32_bf16 v[112:115], v[8:11], v[28:31], v[112:115]
    v_mfma_f32_16x16x32_bf16 v[128:131], v[8:11], v[32:35], v[128:131]
    v_mfma_f32_16x16x32_bf16 v[144:147], v[8:11], v[36:39], v[144:147]
    s_waitcnt lgkmcnt(2)
    v_mfma_f32_16x16x32_bf16 v[68:71], v[160:163], v[16:19], v[68:71]
    ds_read_b64_tr_b16 v[8:9], v15 offset:10240
    v_mfma_f32_16x16x32_bf16 v[84:87], v[160:163], v[20:23], v[84:87]
    ds_read_b64_tr_b16 v[10:11], v15 offset:11264
    v_mfma_f32_16x16x32_bf16 v[100:103], v[160:163], v[24:27], v[100:103]
    v_mfma_f32_16x16x32_bf16 v[116:119], v[160:163], v[28:31], v[116:119]
    v_mfma_f32_16x16x32_bf16 v[132:135], v[160:163], v[32:35], v[132:135]
    v_mfma_f32_16x16x32_bf16 v[148:151], v[160:163], v[36:39], v[148:151]
    s_waitcnt lgkmcnt(2)
    v_mfma_f32_16x16x32_bf16 v[72:75], v[164:167], v[16:19], v[72:75]
    ds_read_b64_tr_b16 v[160:161], v12 offset:15360
    v_mfma_f32_16x16x32_bf16 v[88:91], v[164:167], v[20:23], v[88:91]
    ds_read_b64_tr_b16 v[162:163], v12 offset:16384
    v_mfma_f32_16x16x32_bf16 v[104:107], v[164:167], v[24:27], v[104:107]
    v_mfma_f32_16x16x32_bf16 v[120:123], v[164:167], v[28:31], v[120:123]
    v_mfma_f32_16x16x32_bf16 v[136:139], v[164:167], v[32:35], v[136:139]
    v_mfma_f32_16x16x32_bf16 v[152:155], v[164:167], v[36:39], v[152:155]
    s_waitcnt lgkmcnt(2)
    v_mfma_f32_16x16x32_bf16 v[76:79], v[8:11], v[16:19], v[76:79]
    ds_read_b64_tr_b16 v[164:165], v13 offset:15360
    buffer_load_dwordx2 v[16:17], v6, s[16:19], s34 offen offset:0 sc1
    buffer_load_dwordx2 v[18:19], v6, s[16:19], s34 offen offset:256 sc1
    v_mfma_f32_16x16x32_bf16 v[92:95], v[8:11], v[20:23], v[92:95]
    ds_read_b64_tr_b16 v[166:167], v13 offset:16384
    buffer_load_dwordx2 v[20:21], v6, s[16:19], s34 offen offset:128 sc1
    buffer_load_dwordx2 v[22:23], v6, s[16:19], s34 offen offset:384 sc1
    v_mfma_f32_16x16x32_bf16 v[108:111], v[8:11], v[24:27], v[108:111]
    buffer_load_dwordx2 v[24:25], v6, s[16:19], s35 offen offset:0 sc1
    buffer_load_dwordx2 v[26:27], v6, s[16:19], s35 offen offset:256 sc1
    v_mfma_f32_16x16x32_bf16 v[124:127], v[8:11], v[28:31], v[124:127]
    buffer_load_dwordx2 v[28:29], v6, s[16:19], s35 offen offset:128 sc1
    buffer_load_dwordx2 v[30:31], v6, s[16:19], s35 offen offset:384 sc1
    v_mfma_f32_16x16x32_bf16 v[140:143], v[8:11], v[32:35], v[140:143]
    buffer_load_dwordx2 v[32:33], v6, s[16:19], s36 offen offset:0 sc1
    buffer_load_dwordx2 v[34:35], v6, s[16:19], s36 offen offset:256 sc1
    v_mfma_f32_16x16x32_bf16 v[156:159], v[8:11], v[36:39], v[156:159]
    buffer_load_dwordx2 v[36:37], v6, s[16:19], s36 offen offset:128 sc1
    buffer_load_dwordx2 v[38:39], v6, s[16:19], s36 offen offset:384 sc1
    s_waitcnt vmcnt(12)
    s_waitcnt lgkmcnt(2)
    v_mfma_f32_16x16x32_bf16 v[64:67], v[160:163], v[40:43], v[64:67]
    ds_read_b64_tr_b16 v[8:9], v14 offset:15360
    v_mfma_f32_16x16x32_bf16 v[80:83], v[160:163], v[44:47], v[80:83]
    ds_read_b64_tr_b16 v[10:11], v14 offset:16384
    v_mfma_f32_16x16x32_bf16 v[96:99], v[160:163], v[48:51], v[96:99]
    v_mfma_f32_16x16x32_bf16 v[112:115], v[160:163], v[52:55], v[112:115]
    v_mfma_f32_16x16x32_bf16 v[128:131], v[160:163], v[56:59], v[128:131]
    v_mfma_f32_16x16x32_bf16 v[144:147], v[160:163], v[60:63], v[144:147]
    s_waitcnt lgkmcnt(2)
    v_mfma_f32_16x16x32_bf16 v[68:71], v[164:167], v[40:43], v[68:71]
    ds_read_b64_tr_b16 v[160:161], v15 offset:15360
    v_mfma_f32_16x16x32_bf16 v[84:87], v[164:167], v[44:47], v[84:87]
    ds_read_b64_tr_b16 v[162:163], v15 offset:16384
    v_mfma_f32_16x16x32_bf16 v[100:103], v[164:167], v[48:51], v[100:103]
    v_mfma_f32_16x16x32_bf16 v[116:119], v[164:167], v[52:55], v[116:119]
    v_mfma_f32_16x16x32_bf16 v[132:135], v[164:167], v[56:59], v[132:135]
    v_mfma_f32_16x16x32_bf16 v[148:151], v[164:167], v[60:63], v[148:151]
    s_waitcnt lgkmcnt(2)
    v_mfma_f32_16x16x32_bf16 v[72:75], v[8:11], v[40:43], v[72:75]
    v_mov_b32 v12, v7
    v_mfma_f32_16x16x32_bf16 v[88:91], v[8:11], v[44:47], v[88:91]
    v_xor_b32 v13, 32, v7
    v_mfma_f32_16x16x32_bf16 v[104:107], v[8:11], v[48:51], v[104:107]
    v_xor_b32 v14, 64, v7
    v_mfma_f32_16x16x32_bf16 v[120:123], v[8:11], v[52:55], v[120:123]
    v_xor_b32 v15, 0x60, v7
    v_mfma_f32_16x16x32_bf16 v[136:139], v[8:11], v[56:59], v[136:139]
    ds_read_b64_tr_b16 v[164:165], v12 offset:2048
    v_mfma_f32_16x16x32_bf16 v[152:155], v[8:11], v[60:63], v[152:155]
    ds_read_b64_tr_b16 v[166:167], v14 offset:4608
    s_waitcnt lgkmcnt(2)
    v_mfma_f32_16x16x32_bf16 v[76:79], v[160:163], v[40:43], v[76:79]
    ds_read_b64_tr_b16 v[8:9], v13 offset:2048
    v_mfma_f32_16x16x32_bf16 v[92:95], v[160:163], v[44:47], v[92:95]
    ds_read_b64_tr_b16 v[10:11], v15 offset:4608
    v_mfma_f32_16x16x32_bf16 v[108:111], v[160:163], v[48:51], v[108:111]
    v_mfma_f32_16x16x32_bf16 v[124:127], v[160:163], v[52:55], v[124:127]
    v_mfma_f32_16x16x32_bf16 v[140:143], v[160:163], v[56:59], v[140:143]
    v_mfma_f32_16x16x32_bf16 v[156:159], v[160:163], v[60:63], v[156:159]
    s_waitcnt vmcnt(0)
    s_waitcnt lgkmcnt(2)
    v_mfma_f32_16x16x32_bf16 v[64:67], v[164:167], v[16:19], v[64:67]
    ds_read_b64_tr_b16 v[160:161], v14 offset:2048
    buffer_load_dwordx4 v[40:43], v3, s[40:43], s20 offen
    v_mfma_f32_16x16x32_bf16 v[80:83], v[164:167], v[20:23], v[80:83]
    ds_read_b64_tr_b16 v[162:163], v12 offset:4608
    buffer_load_dwordx4 v[44:47], v3, s[40:43], s21 offen
    v_mfma_f32_16x16x32_bf16 v[96:99], v[164:167], v[24:27], v[96:99]
    buffer_load_dwordx4 v[48:51], v3, s[40:43], s22 offen
    v_mfma_f32_16x16x32_bf16 v[112:115], v[164:167], v[28:31], v[112:115]
    v_lshrrev_b32 v52, 3, v0
    v_mfma_f32_16x16x32_bf16 v[128:131], v[164:167], v[32:35], v[128:131]
    v_mul_u32_u24 v52, 272, v52
    v_mfma_f32_16x16x32_bf16 v[144:147], v[164:167], v[36:39], v[144:147]
    v_and_b32 v53, 7, v0
    s_waitcnt lgkmcnt(2)
    v_mfma_f32_16x16x32_bf16 v[68:71], v[8:11], v[16:19], v[68:71]
    ds_read_b64_tr_b16 v[164:165], v15 offset:2048
    v_lshl_add_u32 v52, v53, 5, v52
    v_mfma_f32_16x16x32_bf16 v[84:87], v[8:11], v[20:23], v[84:87]
    ds_read_b64_tr_b16 v[166:167], v13 offset:4608
    s_mul_i32 s3, s24, 2176
    v_mfma_f32_16x16x32_bf16 v[100:103], v[8:11], v[24:27], v[100:103]
    s_add_u32 s3, s3, 32768
    v_mfma_f32_16x16x32_bf16 v[116:119], v[8:11], v[28:31], v[116:119]
    v_add_u32 v52, s3, v52
    v_mfma_f32_16x16x32_bf16 v[132:135], v[8:11], v[32:35], v[132:135]
    v_add_u32 v53, 61440, v52
    v_mfma_f32_16x16x32_bf16 v[148:151], v[8:11], v[36:39], v[148:151]
    v_mul_u32_u24 v60, 272, v4
    s_waitcnt lgkmcnt(2)
    v_mfma_f32_16x16x32_bf16 v[72:75], v[160:163], v[16:19], v[72:75]
    v_lshl_add_u32 v60, v1, 4, v60
    v_mfma_f32_16x16x32_bf16 v[88:91], v[160:163], v[20:23], v[88:91]
    v_add_u32 v60, s15, v60
    v_mfma_f32_16x16x32_bf16 v[104:107], v[160:163], v[24:27], v[104:107]
    v_mov_b32 v54, s57
    v_mfma_f32_16x16x32_bf16 v[120:123], v[160:163], v[28:31], v[120:123]
    v_mov_b32 v58, 155892
    v_mfma_f32_16x16x32_bf16 v[136:139], v[160:163], v[32:35], v[136:139]
    s_lshl_b32 s3, s24, 2
    v_mfma_f32_16x16x32_bf16 v[152:155], v[160:163], v[36:39], v[152:155]
    s_add_u32 s3, s3, 155872
    s_waitcnt lgkmcnt(0)
    v_mfma_f32_16x16x32_bf16 v[76:79], v[164:167], v[16:19], v[76:79]
    v_mov_b32 v55, s3
    v_mfma_f32_16x16x32_bf16 v[92:95], v[164:167], v[20:23], v[92:95]
    v_and_b32 v56, 3, v0
    v_mfma_f32_16x16x32_bf16 v[108:111], v[164:167], v[24:27], v[108:111]
    v_lshlrev_b32 v56, 2, v56
    v_mfma_f32_16x16x32_bf16 v[124:127], v[164:167], v[28:31], v[124:127]
    v_add_u32 v56, 155872, v56
    v_mfma_f32_16x16x32_bf16 v[140:143], v[164:167], v[32:35], v[140:143]
    v_mfma_f32_16x16x32_bf16 v[156:159], v[164:167], v[36:39], v[156:159]
    ds_write_b128 v60, v[64:67] offset:0
    ds_write_b128 v60, v[80:83] offset:4352
    ds_write_b128 v60, v[96:99] offset:8704
    ds_write_b128 v60, v[112:115] offset:13056
    ds_write_b128 v60, v[128:131] offset:17408
    ds_write_b128 v60, v[144:147] offset:21760
    ds_write_b128 v60, v[68:71] offset:64
    ds_write_b128 v60, v[84:87] offset:4416
    ds_write_b128 v60, v[100:103] offset:8768
    ds_write_b128 v60, v[116:119] offset:13120
    ds_write_b128 v60, v[132:135] offset:17472
    ds_write_b128 v60, v[148:151] offset:21824
    ds_write_b128 v60, v[72:75] offset:128
    ds_write_b128 v60, v[88:91] offset:4480
    ds_write_b128 v60, v[104:107] offset:8832
    ds_write_b128 v60, v[120:123] offset:13184
    ds_write_b128 v60, v[136:139] offset:17536
    ds_write_b128 v60, v[152:155] offset:21888
    ds_write_b128 v60, v[76:79] offset:192
    ds_write_b128 v60, v[92:95] offset:4544
    ds_write_b128 v60, v[108:111] offset:8896
    ds_write_b128 v60, v[124:127] offset:13248
    ds_write_b128 v60, v[140:143] offset:17600
    ds_write_b128 v60, v[156:159] offset:21952
    v_add_u32 v54, 1, v54
    ds_write_b32 v55, v54
    ds_read_b32 v57, v56
    s_waitcnt lgkmcnt(0)
    v_cmp_lt_u32 vcc, v57, v54
    s_cbranch_vccnz parallel_sum__softmax_full_mha__glu_gated_swiglu__prompt_kernel_fb2s
parallel_sum__softmax_full_mha__glu_gated_swiglu__prompt_kernel_fb2r:
    ds_read_b128 v[64:67], v52 offset:0
    ds_read_b128 v[68:71], v52 offset:16
    ds_read_b128 v[72:75], v52 offset:30720
    ds_read_b128 v[76:79], v52 offset:30736
    ds_read_b128 v[80:83], v53 offset:0
    ds_read_b128 v[84:87], v53 offset:16
    ds_read_b128 v[88:91], v53 offset:30720
    ds_read_b128 v[92:95], v53 offset:30736
    ds_read_b128 v[96:99], v52 offset:8704
    ds_read_b128 v[100:103], v52 offset:8720
    ds_read_b128 v[104:107], v52 offset:39424
    ds_read_b128 v[108:111], v52 offset:39440
    ds_read_b128 v[112:115], v53 offset:8704
    ds_read_b128 v[116:119], v53 offset:8720
    ds_read_b128 v[120:123], v53 offset:39424
    ds_read_b128 v[124:127], v53 offset:39440
    ds_read_b128 v[128:131], v52 offset:17408
    ds_read_b128 v[132:135], v52 offset:17424
    ds_read_b128 v[136:139], v52 offset:48128
    ds_read_b128 v[140:143], v52 offset:48144
    ds_read_b128 v[144:147], v53 offset:17408
    ds_read_b128 v[148:151], v53 offset:17424
    ds_read_b128 v[152:155], v53 offset:48128
    ds_read_b128 v[156:159], v53 offset:48144
    s_waitcnt vmcnt(0)
    s_waitcnt lgkmcnt(15)
    v_pk_add_f32 v[64:65], v[64:65], v[72:73]
    v_pk_add_f32 v[80:81], v[80:81], v[88:89]
    v_lshlrev_b32 v72, 16, v40
    v_and_b32 v73, 0xffff0000, v40
    v_pk_add_f32 v[64:65], v[64:65], v[80:81]
    v_pk_add_f32 v[64:65], v[64:65], v[72:73]
    v_cvt_pk_bf16_f32 v40, v64, v65
    v_pk_add_f32 v[66:67], v[66:67], v[74:75]
    v_pk_add_f32 v[82:83], v[82:83], v[90:91]
    v_lshlrev_b32 v74, 16, v41
    v_and_b32 v75, 0xffff0000, v41
    v_pk_add_f32 v[66:67], v[66:67], v[82:83]
    v_pk_add_f32 v[66:67], v[66:67], v[74:75]
    v_cvt_pk_bf16_f32 v41, v66, v67
    v_pk_add_f32 v[68:69], v[68:69], v[76:77]
    v_pk_add_f32 v[84:85], v[84:85], v[92:93]
    v_lshlrev_b32 v76, 16, v42
    v_and_b32 v77, 0xffff0000, v42
    v_pk_add_f32 v[68:69], v[68:69], v[84:85]
    v_pk_add_f32 v[68:69], v[68:69], v[76:77]
    v_cvt_pk_bf16_f32 v42, v68, v69
    v_pk_add_f32 v[70:71], v[70:71], v[78:79]
    v_pk_add_f32 v[86:87], v[86:87], v[94:95]
    v_lshlrev_b32 v78, 16, v43
    v_and_b32 v79, 0xffff0000, v43
    v_pk_add_f32 v[70:71], v[70:71], v[86:87]
    v_pk_add_f32 v[70:71], v[70:71], v[78:79]
    v_cvt_pk_bf16_f32 v43, v70, v71
    buffer_store_dwordx4 v[40:43], v3, s[48:51], s20 offen
    s_waitcnt lgkmcnt(8)
    v_pk_add_f32 v[96:97], v[96:97], v[104:105]
    v_pk_add_f32 v[112:113], v[112:113], v[120:121]
    v_lshlrev_b32 v104, 16, v44
    v_and_b32 v105, 0xffff0000, v44
    v_pk_add_f32 v[96:97], v[96:97], v[112:113]
    v_pk_add_f32 v[96:97], v[96:97], v[104:105]
    v_cvt_pk_bf16_f32 v44, v96, v97
    v_pk_add_f32 v[98:99], v[98:99], v[106:107]
    v_pk_add_f32 v[114:115], v[114:115], v[122:123]
    v_lshlrev_b32 v106, 16, v45
    v_and_b32 v107, 0xffff0000, v45
    v_pk_add_f32 v[98:99], v[98:99], v[114:115]
    v_pk_add_f32 v[98:99], v[98:99], v[106:107]
    v_cvt_pk_bf16_f32 v45, v98, v99
    v_pk_add_f32 v[100:101], v[100:101], v[108:109]
    v_pk_add_f32 v[116:117], v[116:117], v[124:125]
    v_lshlrev_b32 v108, 16, v46
    v_and_b32 v109, 0xffff0000, v46
    v_pk_add_f32 v[100:101], v[100:101], v[116:117]
    v_pk_add_f32 v[100:101], v[100:101], v[108:109]
    v_cvt_pk_bf16_f32 v46, v100, v101
    v_pk_add_f32 v[102:103], v[102:103], v[110:111]
    v_pk_add_f32 v[118:119], v[118:119], v[126:127]
    v_lshlrev_b32 v110, 16, v47
    v_and_b32 v111, 0xffff0000, v47
    v_pk_add_f32 v[102:103], v[102:103], v[118:119]
    v_pk_add_f32 v[102:103], v[102:103], v[110:111]
    v_cvt_pk_bf16_f32 v47, v102, v103
    buffer_store_dwordx4 v[44:47], v3, s[48:51], s21 offen
    s_waitcnt lgkmcnt(0)
    v_pk_add_f32 v[128:129], v[128:129], v[136:137]
    v_pk_add_f32 v[144:145], v[144:145], v[152:153]
    v_lshlrev_b32 v136, 16, v48
    v_and_b32 v137, 0xffff0000, v48
    v_pk_add_f32 v[128:129], v[128:129], v[144:145]
    v_pk_add_f32 v[128:129], v[128:129], v[136:137]
    v_cvt_pk_bf16_f32 v48, v128, v129
    v_pk_add_f32 v[130:131], v[130:131], v[138:139]
    v_pk_add_f32 v[146:147], v[146:147], v[154:155]
    v_lshlrev_b32 v138, 16, v49
    v_and_b32 v139, 0xffff0000, v49
    v_pk_add_f32 v[130:131], v[130:131], v[146:147]
    v_pk_add_f32 v[130:131], v[130:131], v[138:139]
    v_cvt_pk_bf16_f32 v49, v130, v131
    v_pk_add_f32 v[132:133], v[132:133], v[140:141]
    v_pk_add_f32 v[148:149], v[148:149], v[156:157]
    v_lshlrev_b32 v140, 16, v50
    v_and_b32 v141, 0xffff0000, v50
    v_pk_add_f32 v[132:133], v[132:133], v[148:149]
    v_pk_add_f32 v[132:133], v[132:133], v[140:141]
    v_cvt_pk_bf16_f32 v50, v132, v133
    v_pk_add_f32 v[134:135], v[134:135], v[142:143]
    v_pk_add_f32 v[150:151], v[150:151], v[158:159]
    v_lshlrev_b32 v142, 16, v51
    v_and_b32 v143, 0xffff0000, v51
    v_pk_add_f32 v[134:135], v[134:135], v[150:151]
    v_pk_add_f32 v[134:135], v[134:135], v[142:143]
    v_cvt_pk_bf16_f32 v51, v134, v135
    buffer_store_dwordx4 v[48:51], v3, s[48:51], s22 offen
    s_or_b32 s3, s2, s24
    s_cmp_lg_u32 s3, 0
    s_cbranch_scc1 parallel_sum__softmax_full_mha__glu_gated_swiglu__prompt_kernel_nrst
    s_load_dwordx2 s[52:53], s[0:1], 64
    v_mov_b32 v36, 0
    s_waitcnt lgkmcnt(0)
    s_mov_b32 s44, s52
    s_and_b32 s45, s53, 0xffff
    s_mov_b32 s46, 256
    s_mov_b32 s47, 0x00020000
    s_mov_b64 exec, 1
    buffer_store_dword v36, v36, s[44:47], 0 offen sc1
    s_mov_b64 exec, -1
parallel_sum__softmax_full_mha__glu_gated_swiglu__prompt_kernel_nrst:
    s_endpgm
parallel_sum__softmax_full_mha__glu_gated_swiglu__prompt_kernel_fb0s:
    s_sleep 1
    ds_read_b32 v21, v20
    s_waitcnt lgkmcnt(0)
    v_cmp_lt_u32 vcc, v21, v18
    s_nop 1
    s_cbranch_vccnz parallel_sum__softmax_full_mha__glu_gated_swiglu__prompt_kernel_fb0s
    s_branch parallel_sum__softmax_full_mha__glu_gated_swiglu__prompt_kernel_fb0r
parallel_sum__softmax_full_mha__glu_gated_swiglu__prompt_kernel_fb1s:
    s_sleep 1
    ds_read_b32 v21, v20
    s_waitcnt lgkmcnt(0)
    v_cmp_lt_u32 vcc, v21, v18
    s_nop 1
    s_cbranch_vccnz parallel_sum__softmax_full_mha__glu_gated_swiglu__prompt_kernel_fb1s
    s_branch parallel_sum__softmax_full_mha__glu_gated_swiglu__prompt_kernel_fb1r
parallel_sum__softmax_full_mha__glu_gated_swiglu__prompt_kernel_fb2s:
    s_sleep 1
    ds_read_b32 v57, v56
    ds_read_b32 v59, v58
    s_waitcnt lgkmcnt(0)
    v_cmp_lt_u32 vcc, s59, v59
    s_cbranch_vccz parallel_sum__softmax_full_mha__glu_gated_swiglu__prompt_kernel_j0
    s_barrier
    s_add_u32 s59, s59, 1
parallel_sum__softmax_full_mha__glu_gated_swiglu__prompt_kernel_j0:
    s_waitcnt lgkmcnt(0)
    v_cmp_lt_u32 vcc, v57, v54
    s_nop 1
    s_cbranch_vccnz parallel_sum__softmax_full_mha__glu_gated_swiglu__prompt_kernel_fb2s
    s_branch parallel_sum__softmax_full_mha__glu_gated_swiglu__prompt_kernel_fb2r
parallel_sum__softmax_full_mha__glu_gated_swiglu__prompt_kernel_csync:
    s_mov_b32 s35, 99
    v_add_u32 v18, 1, v18
    s_waitcnt vmcnt(10) lgkmcnt(0)
    ds_write_b32 v19, v18
parallel_sum__softmax_full_mha__glu_gated_swiglu__prompt_kernel_cs2:
    ds_read_b32 v21, v20
    s_waitcnt lgkmcnt(0)
    v_cmp_lt_u32 vcc, v21, v18
    s_cbranch_vccz parallel_sum__softmax_full_mha__glu_gated_swiglu__prompt_kernel_cs3
    s_sleep 1
    s_branch parallel_sum__softmax_full_mha__glu_gated_swiglu__prompt_kernel_cs2
parallel_sum__softmax_full_mha__glu_gated_swiglu__prompt_kernel_cs3:
    s_setprio 0
    s_branch parallel_sum__softmax_full_mha__glu_gated_swiglu__prompt_kernel_gback
parallel_sum__softmax_full_mha__glu_gated_swiglu__prompt_kernel_gsync:
    ds_read_b32 v23, v22 offset:12
    v_add_u32 v18, 1, v18
    s_waitcnt vmcnt(10) lgkmcnt(0)
    v_readfirstlane_b32 s3, v23
    s_cmp_eq_u32 s24, 0
    s_cselect_b32 s3, s3, 0
    s_cmp_eq_u32 s3, 0
    s_cbranch_scc1 parallel_sum__softmax_full_mha__glu_gated_swiglu__prompt_kernel_gs1
    ds_write_b32 v22, v18 offset:16
parallel_sum__softmax_full_mha__glu_gated_swiglu__prompt_kernel_gs1:
    ds_write_b32 v19, v18
parallel_sum__softmax_full_mha__glu_gated_swiglu__prompt_kernel_gs2:
    ds_read_b32 v21, v20
    ds_read_b32 v23, v22 offset:16
    s_waitcnt lgkmcnt(0)
    v_cmp_lt_u32 vcc, v21, v18
    s_cbranch_vccnz parallel_sum__softmax_full_mha__glu_gated_swiglu__prompt_kernel_gs2
    v_cmp_le_u32 vcc, v23, v18
    s_setprio 1
    s_cbranch_vccnz parallel_sum__softmax_full_mha__glu_gated_swiglu__prompt_kernel_gs4
    s_cmp_gt_u32 s13, 8
    s_cbranch_scc1 parallel_sum__softmax_full_mha__glu_gated_swiglu__prompt_kernel_gback
parallel_sum__softmax_full_mha__glu_gated_swiglu__prompt_kernel_gs3:
    s_sleep 1
    ds_read_b32 v23, v22 offset:12
    s_waitcnt lgkmcnt(0)
    v_cmp_gt_u32 vcc, 33, v23
    s_cbranch_vccnz parallel_sum__softmax_full_mha__glu_gated_swiglu__prompt_kernel_gs3
parallel_sum__softmax_full_mha__glu_gated_swiglu__prompt_kernel_gs4:
    s_mov_b32 s56, 16
    s_setprio 0
    s_branch parallel_sum__softmax_full_mha__glu_gated_swiglu__prompt_kernel_gback
parallel_sum__softmax_full_mha__glu_gated_swiglu__prompt_kernel_pf2:
    s_mov_b32 s48, s52
    s_and_b32 s49, s53, 0xffff
    s_mov_b32 s50, 1966080
    s_mov_b32 s51, 0x00020000
    s_mov_b32 s44, s94
    s_and_b32 s45, s95, 0xffff
    s_mov_b32 s46, 819200
    s_mov_b32 s47, 0x00020000
    s_sub_u32 s3, s2, 240
    s_cmp_eq_u32 0, 1
    s_cselect_b32 s3, s10, s3
    s_lshl_b32 s3, s3, 2
    s_add_u32 s3, s3, s24
    s_lshl_b32 s13, s3, 10
    s_lshr_b32 s58, s3, 4
    s_mul_i32 s58, s58, 491520
    s_and_b32 s3, s3, 15
    s_lshl_b32 s3, s3, 10
    s_add_u32 s3, s3, s58
    s_add_u32 s3, s3, 245760
    buffer_load_dwordx4 v[64:67], v2, s[48:51], s3 offen
    s_add_u32 s3, s3, 16384
    buffer_load_dwordx4 v[68:71], v2, s[48:51], s3 offen
    s_add_u32 s3, s3, 16384
    buffer_load_dwordx4 v[72:75], v2, s[48:51], s3 offen
    s_add_u32 s3, s3, 16384
    buffer_load_dwordx4 v[76:79], v2, s[48:51], s3 offen
    s_add_u32 s3, s3, 16384
    buffer_load_dwordx4 v[80:83], v2, s[48:51], s3 offen
    s_add_u32 s3, s3, 16384
    s_cmp_ge_u32 s59, s56
    s_cbranch_scc1 parallel_sum__softmax_full_mha__glu_gated_swiglu__prompt_kernel_cb14
    s_barrier
    s_add_u32 s59, s59, 1
parallel_sum__softmax_full_mha__glu_gated_swiglu__prompt_kernel_cb14:
    buffer_load_dwordx4 v[84:87], v2, s[48:51], s3 offen
    s_add_u32 s3, s3, 16384
    buffer_load_dwordx4 v[88:91], v2, s[48:51], s3 offen
    s_add_u32 s3, s3, 16384
    buffer_load_dwordx4 v[92:95], v2, s[48:51], s3 offen
    s_add_u32 s3, s3, 16384
    buffer_load_dwordx4 v[96:99], v2, s[48:51], s3 offen
    s_add_u32 s3, s3, 16384
    buffer_load_dwordx4 v[100:103], v2, s[48:51], s3 offen
    s_add_u32 s3, s3, 16384
    s_cmp_ge_u32 s59, s56
    s_cbranch_scc1 parallel_sum__softmax_full_mha__glu_gated_swiglu__prompt_kernel_cb15
    s_barrier
    s_add_u32 s59, s59, 1
parallel_sum__softmax_full_mha__glu_gated_swiglu__prompt_kernel_cb15:
    buffer_load_dwordx4 v[104:107], v2, s[48:51], s3 offen
    s_add_u32 s3, s3, 16384
    buffer_load_dwordx4 v[108:111], v2, s[48:51], s3 offen
    s_add_u32 s3, s3, 16384
    buffer_load_dwordx4 v[112:115], v2, s[48:51], s3 offen
    s_add_u32 s3, s3, 16384
    buffer_load_dwordx4 v[116:119], v2, s[48:51], s3 offen
    s_add_u32 s3, s3, 16384
    buffer_load_dwordx4 v[120:123], v2, s[48:51], s3 offen
    s_add_u32 s3, s3, 16384
    s_cmp_ge_u32 s59, s56
    s_cbranch_scc1 parallel_sum__softmax_full_mha__glu_gated_swiglu__prompt_kernel_cb16
    s_barrier
    s_add_u32 s59, s59, 1
parallel_sum__softmax_full_mha__glu_gated_swiglu__prompt_kernel_cb16:
    s_endpgm
parallel_sum__softmax_full_mha__glu_gated_swiglu__prompt_kernel_fidle:
    s_waitcnt vmcnt(0) lgkmcnt(0)
    s_barrier
    s_barrier
    s_barrier
    s_barrier
    s_barrier
    s_barrier
    s_barrier
    s_barrier
    s_barrier
    s_barrier
    s_barrier
    v_mov_b32 v12, 155900
    ds_read_b32 v12, v12
    s_waitcnt lgkmcnt(0)
    v_readfirstlane_b32 s99, v12
    s_branch parallel_sum__softmax_full_mha__glu_gated_swiglu__prompt_kernel_pa_r
parallel_sum__softmax_full_mha__glu_gated_swiglu__prompt_kernel_help:
    s_setprio 3
    s_sub_u32 s28, s12, 4
    s_memrealtime s[40:41]
    s_load_dwordx2 s[44:45], s[0:1], 16
    s_load_dwordx4 s[48:51], s[0:1], 32
    s_load_dwordx2 s[46:47], s[0:1], 48
    v_and_b32 v1, 7, v0
    v_lshrrev_b32 v2, 3, v0
    s_lshl_b32 s3, s28, 3
    v_add_u32 v2, s3, v2
    s_lshl_b32 s29, s10, 7
    s_lshl_b32 s3, s11, 3
    s_add_u32 s29, s29, s3
    v_add_u32 v3, s29, v1
    v_mul_u32_u24 v4, 1280, v3
    v_lshl_add_u32 v4, v2, 4, v4
    s_cmp_lt_u32 s28, 2
    s_mov_b32 s30, 0x7f000000
    s_cselect_b32 s30, 0, s30
    v_add_u32 v5, s30, v4
    v_mov_b32 v6, 0
    s_waitcnt lgkmcnt(0)
    s_mov_b32 s20, s4
    s_and_b32 s21, s5, 0xffff
    s_mov_b32 s22, 2621440
    s_mov_b32 s23, 0x00020000
    s_mov_b32 s24, s92
    s_and_b32 s25, s93, 0xffff
    s_mov_b32 s26, 256
    s_mov_b32 s27, 0x00020000
    s_mov_b32 s16, s94
    s_and_b32 s17, s95, 0xffff
    buffer_load_dwordx4 v[8:11], v4, s[20:23], 0 offen
    buffer_load_dwordx4 v[12:15], v4, s[20:23], 0 offen offset:512
    buffer_load_dwordx4 v[16:19], v5, s[20:23], 0 offen offset:1024
    v_lshlrev_b32 v58, 7, v0
    s_or_b32 s3, s2, s28
    s_cmp_lg_u32 s3, 0
    s_cbranch_scc1 parallel_sum__softmax_full_mha__glu_gated_swiglu__prompt_kernel_nononce
    s_or_b32 s40, s40, 1
    v_mov_b32 v7, s40
    s_mov_b64 exec, 1
    buffer_store_dword v7, v6, s[24:27], 0 offen sc1
    s_mov_b64 exec, -1
parallel_sum__softmax_full_mha__glu_gated_swiglu__prompt_kernel_nononce:
    v_lshrrev_b32 v7, 5, v3
    v_mul_u32_u24 v7, 40960, v7
    v_lshrrev_b32 v20, 2, v2
    v_lshl_add_u32 v7, v20, 11, v7
    v_and_b32 v20, 3, v2
    v_lshl_add_u32 v7, v20, 8, v7
    v_bfe_u32 v20, v3, 4, 1
    v_lshl_add_u32 v7, v20, 10, v7
    v_and_b32 v20, 15, v3
    v_lshl_add_u32 v7, v20, 4, v7
    v_add_u32 v21, 16384, v7
    v_add_u32 v22, 32768, v7
    v_add_u32 v22, s30, v22
    s_lshl_b32 s3, s28, 6
    v_lshl_add_u32 v23, v1, 3, s3
    v_add_u32 v23, 157696, v23
    v_lshlrev_b32 v24, 3, v1
    v_add_u32 v24, 157696, v24
    v_mov_b32 v26, 0
    v_mov_b32 v27, 0
    s_barrier
    s_waitcnt vmcnt(0)
    v_lshlrev_b32 v32, 16, v8
    v_and_b32 v33, 0xffff0000, v8
    v_add_f32 v26, v26, v32
    v_fmac_f32 v27, v32, v32
    v_add_f32 v26, v26, v33
    v_fmac_f32 v27, v33, v33
    v_lshlrev_b32 v34, 16, v9
    v_and_b32 v35, 0xffff0000, v9
    v_add_f32 v26, v26, v34
    v_fmac_f32 v27, v34, v34
    v_add_f32 v26, v26, v35
    v_fmac_f32 v27, v35, v35
    v_lshlrev_b32 v36, 16, v10
    v_and_b32 v37, 0xffff0000, v10
    v_add_f32 v26, v26, v36
    v_fmac_f32 v27, v36, v36
    v_add_f32 v26, v26, v37
    v_fmac_f32 v27, v37, v37
    v_lshlrev_b32 v38, 16, v11
    v_and_b32 v39, 0xffff0000, v11
    v_add_f32 v26, v26, v38
    v_fmac_f32 v27, v38, v38
    v_add_f32 v26, v26, v39
    v_fmac_f32 v27, v39, v39
    v_lshlrev_b32 v40, 16, v12
    v_and_b32 v41, 0xffff0000, v12
    v_add_f32 v26, v26, v40
    v_fmac_f32 v27, v40, v40
    v_add_f32 v26, v26, v41
    v_fmac_f32 v27, v41, v41
    v_lshlrev_b32 v42, 16, v13
    v_and_b32 v43, 0xffff0000, v13
    v_add_f32 v26, v26, v42
    v_fmac_f32 v27, v42, v42
    v_add_f32 v26, v26, v43
    v_fmac_f32 v27, v43, v43
    v_lshlrev_b32 v44, 16, v14
    v_and_b32 v45, 0xffff0000, v14
    v_add_f32 v26, v26, v44
    v_fmac_f32 v27, v44, v44
    v_add_f32 v26, v26, v45
    v_fmac_f32 v27, v45, v45
    v_lshlrev_b32 v46, 16, v15
    v_and_b32 v47, 0xffff0000, v15
    v_add_f32 v26, v26, v46
    v_fmac_f32 v27, v46, v46
    v_add_f32 v26, v26, v47
    v_fmac_f32 v27, v47, v47
    v_lshlrev_b32 v48, 16, v16
    v_and_b32 v49, 0xffff0000, v16
    v_add_f32 v26, v26, v48
    v_fmac_f32 v27, v48, v48
    v_add_f32 v26, v26, v49
    v_fmac_f32 v27, v49, v49
    v_lshlrev_b32 v50, 16, v17
    v_and_b32 v51, 0xffff0000, v17
    v_add_f32 v26, v26, v50
    v_fmac_f32 v27, v50, v50
    v_add_f32 v26, v26, v51
    v_fmac_f32 v27, v51, v51
    v_lshlrev_b32 v52, 16, v18
    v_and_b32 v53, 0xffff0000, v18
    v_add_f32 v26, v26, v52
    v_fmac_f32 v27, v52, v52
    v_add_f32 v26, v26, v53
    v_fmac_f32 v27, v53, v53
    v_lshlrev_b32 v54, 16, v19
    v_and_b32 v55, 0xffff0000, v19
    v_add_f32 v26, v26, v54
    v_fmac_f32 v27, v54, v54
    v_add_f32 v26, v26, v55
    v_fmac_f32 v27, v55, v55
    s_nop 0
    v_add_f32_dpp v26, v26, v26 row_ror:8 row_mask:0xf bank_mask:0xf
    v_mov_b32 v28, v26
    s_nop 0
    s_nop 0
    v_permlane16_swap_b32 v26, v28
    v_add_f32 v26, v26, v28
    v_mov_b32 v28, v26
    s_nop 0
    s_nop 0
    v_permlane32_swap_b32 v26, v28
    v_add_f32 v26, v26, v28
    v_add_f32_dpp v27, v27, v27 row_ror:8 row_mask:0xf bank_mask:0xf
    v_mov_b32 v28, v27
    s_nop 0
    s_nop 0
    v_permlane16_swap_b32 v27, v28
    v_add_f32 v27, v27, v28
    v_mov_b32 v28, v27
    s_nop 0
    s_nop 0
    v_permlane32_swap_b32 v27, v28
    v_add_f32 v27, v27, v28
    ds_write_b64 v23, v[26:27]
    s_waitcnt lgkmcnt(0)
    s_barrier
    ds_read_b64 v[26:27], v24
    ds_read_b64 v[28:29], v24 offset:64
    ds_read_b64 v[30:31], v24 offset:128
    ds_read_b64 v[56:57], v24 offset:192
    buffer_load_dword v25, v6, s[24:27], 0 offen sc1
    s_waitcnt lgkmcnt(0)
    v_add_f32 v26, v26, v28
    v_add_f32 v27, v27, v29
    v_add_f32 v30, v30, v56
    v_add_f32 v31, v31, v57
    v_add_f32 v26, v26, v30
    v_add_f32 v27, v27, v31
    v_mul_f32 v26, 0x3acccccd, v26
    v_mul_f32 v27, 0x3acccccd, v27
    v_fma_f32 v27, -v26, v26, v27
    v_max_f32 v27, 0, v27
    v_cvt_pk_bf16_f32 v28, v26, v27
    v_lshlrev_b32 v26, 16, v28
    v_and_b32 v27, 0xffff0000, v28
    v_add_f32 v27, 0x3727c5ac, v27
    v_cvt_pk_bf16_f32 v27, v27, v27
    v_and_b32 v27, 0xffff0000, v27
    v_sqrt_f32 v27, v27
    s_nop 0
    v_cvt_pk_bf16_f32 v27, v27, v27
    v_and_b32 v27, 0xffff0000, v27
    v_rcp_f32 v27, v27
    s_mov_b32 s31, 7864320
    v_mul_f32 v30, 0x3fb8aa3b, v27
    v_mul_f32 v28, v26, v30
    v_fma_f32 v32, v32, v30, -v28
    v_fma_f32 v33, v33, v30, -v28
    v_cvt_pk_bf16_f32 v8, v32, v33
    v_fma_f32 v34, v34, v30, -v28
    v_fma_f32 v35, v35, v30, -v28
    v_cvt_pk_bf16_f32 v9, v34, v35
    v_fma_f32 v36, v36, v30, -v28
    v_fma_f32 v37, v37, v30, -v28
    v_cvt_pk_bf16_f32 v10, v36, v37
    v_fma_f32 v38, v38, v30, -v28
    v_fma_f32 v39, v39, v30, -v28
    v_cvt_pk_bf16_f32 v11, v38, v39
    buffer_store_dwordx4 v[8:11], v7, s[16:19], s31 offen sc1
    v_fma_f32 v40, v40, v30, -v28
    v_fma_f32 v41, v41, v30, -v28
    v_cvt_pk_bf16_f32 v12, v40, v41
    v_fma_f32 v42, v42, v30, -v28
    v_fma_f32 v43, v43, v30, -v28
    v_cvt_pk_bf16_f32 v13, v42, v43
    v_fma_f32 v44, v44, v30, -v28
    v_fma_f32 v45, v45, v30, -v28
    v_cvt_pk_bf16_f32 v14, v44, v45
    v_fma_f32 v46, v46, v30, -v28
    v_fma_f32 v47, v47, v30, -v28
    v_cvt_pk_bf16_f32 v15, v46, v47
    buffer_store_dwordx4 v[12:15], v21, s[16:19], s31 offen sc1
    v_fma_f32 v48, v48, v30, -v28
    v_fma_f32 v49, v49, v30, -v28
    v_cvt_pk_bf16_f32 v16, v48, v49
    v_fma_f32 v50, v50, v30, -v28
    v_fma_f32 v51, v51, v30, -v28
    v_cvt_pk_bf16_f32 v17, v50, v51
    v_fma_f32 v52, v52, v30, -v28
    v_fma_f32 v53, v53, v30, -v28
    v_cvt_pk_bf16_f32 v18, v52, v53
    v_fma_f32 v54, v54, v30, -v28
    v_fma_f32 v55, v55, v30, -v28
    v_cvt_pk_bf16_f32 v19, v54, v55
    buffer_store_dwordx4 v[16:19], v22, s[16:19], s31 offen sc1
    s_cmp_lg_u32 s28, 0
    s_cbranch_scc1 parallel_sum__softmax_full_mha__glu_gated_swiglu__prompt_kernel_nostat
    v_lshlrev_b32 v29, 3, v3
    s_mov_b32 s31, 24924160
    s_mov_b64 exec, 0xff
    buffer_store_dwordx2 v[26:27], v29, s[16:19], s31 offen sc1
    s_mov_b64 exec, -1
parallel_sum__softmax_full_mha__glu_gated_swiglu__prompt_kernel_nostat:
    s_barrier
    s_barrier
    s_mov_b32 s13, 0x100000
parallel_sum__softmax_full_mha__glu_gated_swiglu__prompt_kernel_nn_l:
    s_waitcnt vmcnt(0)
    v_readfirstlane_b32 s99, v25
    s_sub_u32 s13, s13, 1
    s_cmp_eq_u32 s13, 0
    s_cbranch_scc1 parallel_sum__softmax_full_mha__glu_gated_swiglu__prompt_kernel_nn_r
    s_cmp_lg_u32 s99, 0
    s_cbranch_scc1 parallel_sum__softmax_full_mha__glu_gated_swiglu__prompt_kernel_nn_r
    buffer_load_dword v25, v6, s[24:27], 0 offen sc1
    s_branch parallel_sum__softmax_full_mha__glu_gated_swiglu__prompt_kernel_nn_l
parallel_sum__softmax_full_mha__glu_gated_swiglu__prompt_kernel_nn_r:
    s_lshl_b32 s31, s10, 8
    s_add_u32 s31, s31, 24915968
    s_lshl_b32 s3, s11, 4
    s_add_u32 s33, s3, s31
    s_mov_b64 exec, 1
    v_mov_b32 v28, 155924
    v_mov_b32 v29, 1
    ds_add_rtn_u32 v29, v28, v29
    v_mov_b32 v28, 0
    v_mov_b32 v30, s99
    s_waitcnt lgkmcnt(0)
    v_cmp_eq_u32 vcc, 3, v29
    s_cbranch_vccz parallel_sum__softmax_full_mha__glu_gated_swiglu__prompt_kernel_sg1
    buffer_store_dword v30, v28, s[16:19], s33 offen sc1
parallel_sum__softmax_full_mha__glu_gated_swiglu__prompt_kernel_sg1:
    s_mov_b64 exec, -1
    v_mov_b32 v26, 155900
    ds_write_b32 v26, v25
    v_and_b32 v27, 15, v0
    v_lshlrev_b32 v27, 4, v27
    s_mov_b32 s31, 24915968
    v_mov_b32 v28, s10
    v_mov_b32 v29, s11
    v_cmp_gt_u32 vcc, 32, v0
    s_nop 1
    v_cndmask_b32 v28, v29, v28, vcc
    v_lshl_add_u32 v27, v28, 8, v27
    s_waitcnt lgkmcnt(0)
    s_barrier
    s_barrier
    s_barrier
    s_cmp_lg_u32 s28, 0
    s_cbranch_scc1 parallel_sum__softmax_full_mha__glu_gated_swiglu__prompt_kernel_hrest
    buffer_load_dword v28, v27, s[16:19], s31 offen sc1
    s_barrier
    s_mov_b32 s13, 0x100000
parallel_sum__softmax_full_mha__glu_gated_swiglu__prompt_kernel_ha_l:
    s_waitcnt vmcnt(0)
    v_cmp_ne_u32 vcc, s99, v28
    s_sub_u32 s13, s13, 1
    s_cmp_eq_u32 s13, 0
    s_cbranch_scc1 parallel_sum__softmax_full_mha__glu_gated_swiglu__prompt_kernel_ha_r
    s_cbranch_vccz parallel_sum__softmax_full_mha__glu_gated_swiglu__prompt_kernel_ha_r
    buffer_load_dword v28, v27, s[16:19], s31 offen sc1
    s_branch parallel_sum__softmax_full_mha__glu_gated_swiglu__prompt_kernel_ha_l
parallel_sum__softmax_full_mha__glu_gated_swiglu__prompt_kernel_ha_r:
    s_lshl_b32 s3, s10, 10
    s_add_u32 s3, s3, 24924160
    v_lshlrev_b32 v30, 4, v0
    buffer_load_dwordx4 v[32:35], v30, s[16:19], s3 offen sc1
    v_lshlrev_b32 v29, 3, v0
    v_add_u32 v29, 156160, v29
    s_barrier
    s_barrier
    s_waitcnt vmcnt(0)
    ds_write2_b32 v29, v32, v34 offset0:0 offset1:1
    ds_write2_b32 v29, v33, v35 offset0:128 offset1:129
    s_waitcnt lgkmcnt(0)
    s_branch parallel_sum__softmax_full_mha__glu_gated_swiglu__prompt_kernel_h10
parallel_sum__softmax_full_mha__glu_gated_swiglu__prompt_kernel_hrest:
    s_barrier
    s_barrier
    s_barrier
parallel_sum__softmax_full_mha__glu_gated_swiglu__prompt_kernel_h10:
    s_barrier
    s_barrier
    s_branch parallel_sum__softmax_full_mha__glu_gated_swiglu__prompt_kernel_att
parallel_sum__softmax_full_mha__glu_gated_swiglu__prompt_kernel_mfma:
    s_setprio 2
    s_lshr_b32 s28, s12, 1
    s_and_b32 s29, s12, 1
    v_and_b32 v56, 15, v0
    v_lshrrev_b32 v57, 4, v0
    v_and_b32 v62, 8, v0
    v_add_u32 v62, v62, v56
    s_lshl_b32 s3, s28, 13
    v_lshl_add_u32 v8, v62, 7, s3
    v_lshrrev_b32 v9, 1, v56
    v_xor_b32 v9, v9, v57
    v_lshl_add_u32 v2, v9, 4, v8
    v_xor_b32 v3, 64, v2
    v_bfe_u32 v8, v0, 2, 2
    v_lshl_add_u32 v9, v57, 3, v8
    v_lshlrev_b32 v9, 8, v9
    s_lshl_b32 s35, s29, 1
    s_or_b32 s35, s35, s28
    v_xor_b32 v8, s35, v8
    v_lshl_add_u32 v9, v8, 6, v9
    v_and_b32 v63, 1, v57
    v_lshl_add_u32 v9, v63, 5, v9
    v_and_b32 v8, 3, v0
    v_lshl_add_u32 v9, v8, 3, v9
    v_add_u32 v4, 0x4000, v9
    v_xor_b32 v5, 32, v4
    v_xor_b32 v6, 64, v4
    v_xor_b32 v7, 0x60, v4
    v_mov_b32 v12, 0x3f803f80
    v_mov_b32 v13, 0x3f803f80
    v_mov_b32 v14, 0x3f803f80
    v_mov_b32 v15, 0x3f803f80
    v_mov_b32 v48, 0
    v_mov_b32 v49, 0
    v_mov_b32 v50, 0
    v_mov_b32 v51, 0
    v_mov_b32 v52, 0
    v_mov_b32 v53, 0
    v_mov_b32 v54, 0
    v_mov_b32 v55, 0
    v_mfma_f32_32x32x16_bf16 v[64:79], v[48:51], v[48:51], 0
    v_mfma_f32_32x32x16_bf16 v[80:95], v[48:51], v[48:51], 0
    v_mfma_f32_32x32x16_bf16 v[96:111], v[48:51], v[48:51], 0
    v_mfma_f32_32x32x16_bf16 v[112:127], v[48:51], v[48:51], 0
    s_waitcnt lgkmcnt(0)
    s_mov_b32 s16, s94
    s_and_b32 s17, s95, 0xffff
    s_mov_b32 s36, 0
    s_cmp_eq_u32 s11, 15
    s_cbranch_scc1 parallel_sum__softmax_full_mha__glu_gated_swiglu__prompt_kernel_mpf
    s_lshl_b32 s3, s35, 7
    v_lshl_add_u32 v61, v56, 2, s3
    v_add_u32 v61, 157184, v61
    s_barrier
    ds_read_b64_tr_b16 v[32:33], v4 offset:0
    ds_read_b64_tr_b16 v[34:35], v4 offset:1024
    ds_read_b128 v[16:19], v2 offset:0
    ds_read_b128 v[20:23], v2 offset:1024
    ds_read_b128 v[24:27], v2 offset:4096
    ds_read_b128 v[28:31], v2 offset:5120
    ds_read_b64_tr_b16 v[36:37], v5 offset:0
    ds_read_b64_tr_b16 v[38:39], v5 offset:1024
    ds_read_b64_tr_b16 v[40:41], v6 offset:0
    ds_read_b64_tr_b16 v[42:43], v6 offset:1024
    ds_read_b64_tr_b16 v[44:45], v7 offset:0
    ds_read_b64_tr_b16 v[46:47], v7 offset:1024
    s_cmp_ge_u32 s11, 10
    s_cbranch_scc1 parallel_sum__softmax_full_mha__glu_gated_swiglu__prompt_kernel_vpath
    s_cmp_lt_u32 s11, 5
    s_cselect_b32 s31, 0x3ea52b5c, 1.0
    s_cselect_b32 s32, 0, 5
    s_cselect_b32 s33, 0, 2621440
    s_sub_u32 s32, s11, s32
    s_lshl_b32 s32, s32, 4
    s_lshl_b32 s3, s35, 2
    s_add_u32 s32, s32, s3
    s_lshl_b32 s32, s32, 15
    s_add_u32 s33, s33, s32
    s_lshl_b32 s3, s10, 1
    s_add_u32 s3, s3, s28
    s_lshl_b32 s3, s3, 10
    s_add_u32 s33, s33, s3
    v_lshrrev_b32 v58, 1, v57
    v_lshlrev_b32 v58, 15, v58
    v_lshl_add_u32 v58, v63, 9, v58
    v_lshl_add_u32 v58, v62, 4, v58
    s_lshl_b32 s3, s28, 8
    v_lshl_add_u32 v59, v62, 2, s3
    v_add_u32 v59, 156160, v59
    s_lshl_b32 s3, s35, 7
    v_lshl_add_u32 v60, v57, 4, s3
    v_add_u32 v60, 157184, v60
    v_xor_b32 v10, 128, v60
    s_mov_b32 s30, 10
.p2align 6
parallel_sum__softmax_full_mha__glu_gated_swiglu__prompt_kernel_loopqk:
    s_waitcnt lgkmcnt(0)
    v_mfma_f32_16x16x32_bf16 v[64:67], v[32:35], v[16:19], v[64:67]
    s_add_u32 s38, s36, 32768
    s_cmp_eq_u32 s38, 98304
    s_cselect_b32 s38, 0, s38
    s_sub_u32 s37, s38, s36
    s_mov_b32 s36, s38
    ds_read_b64_tr_b16 v[144:145], v4 offset:8192
    v_mfma_f32_16x16x32_bf16 v[68:71], v[32:35], v[20:23], v[68:71]
    ds_read_b64_tr_b16 v[146:147], v4 offset:9216
    v_mfma_f32_16x16x32_bf16 v[72:75], v[32:35], v[24:27], v[72:75]
    ds_read_b128 v[128:131], v3 offset:0
    v_mfma_f32_16x16x32_bf16 v[76:79], v[32:35], v[28:31], v[76:79]
    ds_read_b128 v[132:135], v3 offset:1024
    v_mfma_f32_16x16x32_bf16 v[80:83], v[36:39], v[16:19], v[80:83]
    ds_read_b128 v[136:139], v3 offset:4096
    v_mfma_f32_16x16x32_bf16 v[84:87], v[36:39], v[20:23], v[84:87]
    ds_read_b128 v[140:143], v3 offset:5120
    v_mfma_f32_16x16x32_bf16 v[88:91], v[36:39], v[24:27], v[88:91]
    ds_read_b64_tr_b16 v[148:149], v5 offset:8192
    v_mfma_f32_16x16x32_bf16 v[92:95], v[36:39], v[28:31], v[92:95]
    ds_read_b64_tr_b16 v[150:151], v5 offset:9216
    v_mfma_f32_16x16x32_bf16 v[96:99], v[40:43], v[16:19], v[96:99]
    ds_read_b64_tr_b16 v[152:153], v6 offset:8192
    v_mfma_f32_16x16x32_bf16 v[100:103], v[40:43], v[20:23], v[100:103]
    ds_read_b64_tr_b16 v[154:155], v6 offset:9216
    v_mfma_f32_16x16x32_bf16 v[104:107], v[40:43], v[24:27], v[104:107]
    ds_read_b64_tr_b16 v[156:157], v7 offset:8192
    v_mfma_f32_16x16x32_bf16 v[108:111], v[40:43], v[28:31], v[108:111]
    ds_read_b64_tr_b16 v[158:159], v7 offset:9216
    v_mfma_f32_16x16x32_bf16 v[112:115], v[44:47], v[16:19], v[112:115]
    v_mfma_f32_16x16x32_bf16 v[116:119], v[44:47], v[20:23], v[116:119]
    v_mfma_f32_16x16x32_bf16 v[120:123], v[44:47], v[24:27], v[120:123]
    v_mfma_f32_16x16x32_bf16 v[124:127], v[44:47], v[28:31], v[124:127]
    v_mfma_f32_16x16x32_bf16 v[48:51], v[12:15], v[32:35], v[48:51]
    v_mfma_f32_16x16x32_bf16 v[52:55], v[12:15], v[36:39], v[52:55]
    s_cmp_eq_u32 s30, 1
    s_cbranch_scc1 parallel_sum__softmax_full_mha__glu_gated_swiglu__prompt_kernel_finqk
    s_waitcnt lgkmcnt(0)
    v_mfma_f32_16x16x32_bf16 v[64:67], v[144:147], v[128:131], v[64:67]
    s_barrier
    v_add_u32 v4, s37, v4
    v_add_u32 v2, s37, v2
    v_add_u32 v3, s37, v3
    v_add_u32 v5, s37, v5
    v_add_u32 v6, s37, v6
    v_add_u32 v7, s37, v7
    ds_read_b64_tr_b16 v[32:33], v4 offset:0
    v_mfma_f32_16x16x32_bf16 v[68:71], v[144:147], v[132:135], v[68:71]
    ds_read_b64_tr_b16 v[34:35], v4 offset:1024
    v_mfma_f32_16x16x32_bf16 v[72:75], v[144:147], v[136:139], v[72:75]
    ds_read_b128 v[16:19], v2 offset:0
    v_mfma_f32_16x16x32_bf16 v[76:79], v[144:147], v[140:143], v[76:79]
    ds_read_b128 v[20:23], v2 offset:1024
    v_mfma_f32_16x16x32_bf16 v[80:83], v[148:151], v[128:131], v[80:83]
    ds_read_b128 v[24:27], v2 offset:4096
    v_mfma_f32_16x16x32_bf16 v[84:87], v[148:151], v[132:135], v[84:87]
    ds_read_b128 v[28:31], v2 offset:5120
    v_mfma_f32_16x16x32_bf16 v[88:91], v[148:151], v[136:139], v[88:91]
    ds_read_b64_tr_b16 v[36:37], v5 offset:0
    v_mfma_f32_16x16x32_bf16 v[92:95], v[148:151], v[140:143], v[92:95]
    ds_read_b64_tr_b16 v[38:39], v5 offset:1024
    v_mfma_f32_16x16x32_bf16 v[96:99], v[152:155], v[128:131], v[96:99]
    ds_read_b64_tr_b16 v[40:41], v6 offset:0
    v_mfma_f32_16x16x32_bf16 v[100:103], v[152:155], v[132:135], v[100:103]
    ds_read_b64_tr_b16 v[42:43], v6 offset:1024
    v_mfma_f32_16x16x32_bf16 v[104:107], v[152:155], v[136:139], v[104:107]
    ds_read_b64_tr_b16 v[44:45], v7 offset:0
    v_mfma_f32_16x16x32_bf16 v[108:111], v[152:155], v[140:143], v[108:111]
    ds_read_b64_tr_b16 v[46:47], v7 offset:1024
    v_mfma_f32_16x16x32_bf16 v[112:115], v[156:159], v[128:131], v[112:115]
    v_mfma_f32_16x16x32_bf16 v[116:119], v[156:159], v[132:135], v[116:119]
    v_mfma_f32_16x16x32_bf16 v[120:123], v[156:159], v[136:139], v[120:123]
    v_mfma_f32_16x16x32_bf16 v[124:127], v[156:159], v[140:143], v[124:127]
    v_mfma_f32_16x16x32_bf16 v[48:51], v[12:15], v[144:147], v[48:51]
    v_mfma_f32_16x16x32_bf16 v[52:55], v[12:15], v[148:151], v[52:55]
    s_sub_u32 s30, s30, 1
    s_branch parallel_sum__softmax_full_mha__glu_gated_swiglu__prompt_kernel_loopqk
parallel_sum__softmax_full_mha__glu_gated_swiglu__prompt_kernel_finqk:
    s_waitcnt lgkmcnt(0)
    v_mfma_f32_16x16x32_bf16 v[48:51], v[12:15], v[144:147], v[48:51]
    v_mfma_f32_16x16x32_bf16 v[52:55], v[12:15], v[148:151], v[52:55]
    v_mfma_f32_16x16x32_bf16 v[64:67], v[144:147], v[128:131], v[64:67]
    v_mfma_f32_16x16x32_bf16 v[68:71], v[144:147], v[132:135], v[68:71]
    v_mfma_f32_16x16x32_bf16 v[72:75], v[144:147], v[136:139], v[72:75]
    v_mfma_f32_16x16x32_bf16 v[76:79], v[144:147], v[140:143], v[76:79]
    v_mfma_f32_16x16x32_bf16 v[80:83], v[148:151], v[128:131], v[80:83]
    v_mfma_f32_16x16x32_bf16 v[84:87], v[148:151], v[132:135], v[84:87]
    v_mfma_f32_16x16x32_bf16 v[88:91], v[148:151], v[136:139], v[88:91]
    v_mfma_f32_16x16x32_bf16 v[92:95], v[148:151], v[140:143], v[92:95]
    ds_write_b32 v61, v48
    ds_write_b32 v61, v52 offset:64
    v_mfma_f32_16x16x32_bf16 v[96:99], v[152:155], v[128:131], v[96:99]
    v_mfma_f32_16x16x32_bf16 v[100:103], v[152:155], v[132:135], v[100:103]
    v_mfma_f32_16x16x32_bf16 v[104:107], v[152:155], v[136:139], v[104:107]
    s_waitcnt lgkmcnt(0)
    s_barrier
    v_mfma_f32_16x16x32_bf16 v[108:111], v[152:155], v[140:143], v[108:111]
    ds_read_b32 v16, v59 offset:0
    ds_read_b32 v18, v59 offset:512
    ds_read_b32 v20, v59 offset:32
    v_mfma_f32_16x16x32_bf16 v[112:115], v[156:159], v[128:131], v[112:115]
    ds_read_b32 v22, v59 offset:544
    ds_read_b32 v24, v59 offset:128
    ds_read_b32 v26, v59 offset:640
    v_mfma_f32_16x16x32_bf16 v[116:119], v[156:159], v[132:135], v[116:119]
    ds_read_b32 v28, v59 offset:160
    ds_read_b32 v30, v59 offset:672
    ds_read_b128 v[32:35], v60 offset:0
    v_mfma_f32_16x16x32_bf16 v[120:123], v[156:159], v[136:139], v[120:123]
    ds_read_b128 v[36:39], v60 offset:64
    ds_read_b128 v[40:43], v10 offset:0
    ds_read_b128 v[44:47], v10 offset:64
    v_mfma_f32_16x16x32_bf16 v[124:127], v[156:159], v[140:143], v[124:127]
    s_waitcnt lgkmcnt(3)
    v_mul_f32 v18, s31, v18
    v_mul_f32 v22, s31, v22
    v_mul_f32 v26, s31, v26
    v_mul_f32 v30, s31, v30
    s_xor_b32 s34, s33, 0
    v_pk_fma_f32 v[64:65], v[32:33], v[16:17], v[64:65] op_sel_hi:[1,0,1] neg_lo:[0,1,0] neg_hi:[0,1,0]
    v_pk_fma_f32 v[66:67], v[34:35], v[16:17], v[66:67] op_sel_hi:[1,0,1] neg_lo:[0,1,0] neg_hi:[0,1,0]
    v_pk_mul_f32 v[64:65], v[64:65], v[18:19] op_sel_hi:[1,0]
    v_pk_mul_f32 v[66:67], v[66:67], v[18:19] op_sel_hi:[1,0]
    v_cvt_pk_bf16_f32 v64, v64, v65
    v_cvt_pk_bf16_f32 v65, v66, v67
    v_pk_fma_f32 v[72:73], v[32:33], v[24:25], v[72:73] op_sel_hi:[1,0,1] neg_lo:[0,1,0] neg_hi:[0,1,0]
    v_pk_fma_f32 v[74:75], v[34:35], v[24:25], v[74:75] op_sel_hi:[1,0,1] neg_lo:[0,1,0] neg_hi:[0,1,0]
    v_pk_mul_f32 v[72:73], v[72:73], v[26:27] op_sel_hi:[1,0]
    v_pk_mul_f32 v[74:75], v[74:75], v[26:27] op_sel_hi:[1,0]
    v_cvt_pk_bf16_f32 v66, v72, v73
    v_cvt_pk_bf16_f32 v67, v74, v75
    buffer_store_dwordx4 v[64:67], v58, s[16:19], s34 offen offset:0 sc1
    v_pk_fma_f32 v[68:69], v[32:33], v[20:21], v[68:69] op_sel_hi:[1,0,1] neg_lo:[0,1,0] neg_hi:[0,1,0]
    v_pk_fma_f32 v[70:71], v[34:35], v[20:21], v[70:71] op_sel_hi:[1,0,1] neg_lo:[0,1,0] neg_hi:[0,1,0]
    v_pk_mul_f32 v[68:69], v[68:69], v[22:23] op_sel_hi:[1,0]
    v_pk_mul_f32 v[70:71], v[70:71], v[22:23] op_sel_hi:[1,0]
    v_cvt_pk_bf16_f32 v68, v68, v69
    v_cvt_pk_bf16_f32 v69, v70, v71
    v_pk_fma_f32 v[76:77], v[32:33], v[28:29], v[76:77] op_sel_hi:[1,0,1] neg_lo:[0,1,0] neg_hi:[0,1,0]
    v_pk_fma_f32 v[78:79], v[34:35], v[28:29], v[78:79] op_sel_hi:[1,0,1] neg_lo:[0,1,0] neg_hi:[0,1,0]
    v_pk_mul_f32 v[76:77], v[76:77], v[30:31] op_sel_hi:[1,0]
    v_pk_mul_f32 v[78:79], v[78:79], v[30:31] op_sel_hi:[1,0]
    v_cvt_pk_bf16_f32 v70, v76, v77
    v_cvt_pk_bf16_f32 v71, v78, v79
    buffer_store_dwordx4 v[68:71], v58, s[16:19], s34 offen offset:128 sc1
    s_waitcnt lgkmcnt(2)
    s_xor_b32 s34, s33, 65536
    v_pk_fma_f32 v[80:81], v[36:37], v[16:17], v[80:81] op_sel_hi:[1,0,1] neg_lo:[0,1,0] neg_hi:[0,1,0]
    v_pk_fma_f32 v[82:83], v[38:39], v[16:17], v[82:83] op_sel_hi:[1,0,1] neg_lo:[0,1,0] neg_hi:[0,1,0]
    v_pk_mul_f32 v[80:81], v[80:81], v[18:19] op_sel_hi:[1,0]
    v_pk_mul_f32 v[82:83], v[82:83], v[18:19] op_sel_hi:[1,0]
    v_cvt_pk_bf16_f32 v80, v80, v81
    v_cvt_pk_bf16_f32 v81, v82, v83
    v_pk_fma_f32 v[88:89], v[36:37], v[24:25], v[88:89] op_sel_hi:[1,0,1] neg_lo:[0,1,0] neg_hi:[0,1,0]
    v_pk_fma_f32 v[90:91], v[38:39], v[24:25], v[90:91] op_sel_hi:[1,0,1] neg_lo:[0,1,0] neg_hi:[0,1,0]
    v_pk_mul_f32 v[88:89], v[88:89], v[26:27] op_sel_hi:[1,0]
    v_pk_mul_f32 v[90:91], v[90:91], v[26:27] op_sel_hi:[1,0]
    v_cvt_pk_bf16_f32 v82, v88, v89
    v_cvt_pk_bf16_f32 v83, v90, v91
    buffer_store_dwordx4 v[80:83], v58, s[16:19], s34 offen offset:0 sc1
    v_pk_fma_f32 v[84:85], v[36:37], v[20:21], v[84:85] op_sel_hi:[1,0,1] neg_lo:[0,1,0] neg_hi:[0,1,0]
    v_pk_fma_f32 v[86:87], v[38:39], v[20:21], v[86:87] op_sel_hi:[1,0,1] neg_lo:[0,1,0] neg_hi:[0,1,0]
    v_pk_mul_f32 v[84:85], v[84:85], v[22:23] op_sel_hi:[1,0]
    v_pk_mul_f32 v[86:87], v[86:87], v[22:23] op_sel_hi:[1,0]
    v_cvt_pk_bf16_f32 v84, v84, v85
    v_cvt_pk_bf16_f32 v85, v86, v87
    v_pk_fma_f32 v[92:93], v[36:37], v[28:29], v[92:93] op_sel_hi:[1,0,1] neg_lo:[0,1,0] neg_hi:[0,1,0]
    v_pk_fma_f32 v[94:95], v[38:39], v[28:29], v[94:95] op_sel_hi:[1,0,1] neg_lo:[0,1,0] neg_hi:[0,1,0]
    v_pk_mul_f32 v[92:93], v[92:93], v[30:31] op_sel_hi:[1,0]
    v_pk_mul_f32 v[94:95], v[94:95], v[30:31] op_sel_hi:[1,0]
    v_cvt_pk_bf16_f32 v86, v92, v93
    v_cvt_pk_bf16_f32 v87, v94, v95
    buffer_store_dwordx4 v[84:87], v58, s[16:19], s34 offen offset:128 sc1
    s_waitcnt lgkmcnt(1)
    s_xor_b32 s34, s33, 131072
    v_pk_fma_f32 v[96:97], v[40:41], v[16:17], v[96:97] op_sel_hi:[1,0,1] neg_lo:[0,1,0] neg_hi:[0,1,0]
    v_pk_fma_f32 v[98:99], v[42:43], v[16:17], v[98:99] op_sel_hi:[1,0,1] neg_lo:[0,1,0] neg_hi:[0,1,0]
    v_pk_mul_f32 v[96:97], v[96:97], v[18:19] op_sel_hi:[1,0]
    v_pk_mul_f32 v[98:99], v[98:99], v[18:19] op_sel_hi:[1,0]
    v_cvt_pk_bf16_f32 v96, v96, v97
    v_cvt_pk_bf16_f32 v97, v98, v99
    v_pk_fma_f32 v[104:105], v[40:41], v[24:25], v[104:105] op_sel_hi:[1,0,1] neg_lo:[0,1,0] neg_hi:[0,1,0]
    v_pk_fma_f32 v[106:107], v[42:43], v[24:25], v[106:107] op_sel_hi:[1,0,1] neg_lo:[0,1,0] neg_hi:[0,1,0]
    v_pk_mul_f32 v[104:105], v[104:105], v[26:27] op_sel_hi:[1,0]
    v_pk_mul_f32 v[106:107], v[106:107], v[26:27] op_sel_hi:[1,0]
    v_cvt_pk_bf16_f32 v98, v104, v105
    v_cvt_pk_bf16_f32 v99, v106, v107
    buffer_store_dwordx4 v[96:99], v58, s[16:19], s34 offen offset:0 sc1
    v_pk_fma_f32 v[100:101], v[40:41], v[20:21], v[100:101] op_sel_hi:[1,0,1] neg_lo:[0,1,0] neg_hi:[0,1,0]
    v_pk_fma_f32 v[102:103], v[42:43], v[20:21], v[102:103] op_sel_hi:[1,0,1] neg_lo:[0,1,0] neg_hi:[0,1,0]
    v_pk_mul_f32 v[100:101], v[100:101], v[22:23] op_sel_hi:[1,0]
    v_pk_mul_f32 v[102:103], v[102:103], v[22:23] op_sel_hi:[1,0]
    v_cvt_pk_bf16_f32 v100, v100, v101
    v_cvt_pk_bf16_f32 v101, v102, v103
    v_pk_fma_f32 v[108:109], v[40:41], v[28:29], v[108:109] op_sel_hi:[1,0,1] neg_lo:[0,1,0] neg_hi:[0,1,0]
    v_pk_fma_f32 v[110:111], v[42:43], v[28:29], v[110:111] op_sel_hi:[1,0,1] neg_lo:[0,1,0] neg_hi:[0,1,0]
    v_pk_mul_f32 v[108:109], v[108:109], v[30:31] op_sel_hi:[1,0]
    v_pk_mul_f32 v[110:111], v[110:111], v[30:31] op_sel_hi:[1,0]
    v_cvt_pk_bf16_f32 v102, v108, v109
    v_cvt_pk_bf16_f32 v103, v110, v111
    buffer_store_dwordx4 v[100:103], v58, s[16:19], s34 offen offset:128 sc1
    s_waitcnt lgkmcnt(0)
    s_xor_b32 s34, s33, 196608
    v_pk_fma_f32 v[112:113], v[44:45], v[16:17], v[112:113] op_sel_hi:[1,0,1] neg_lo:[0,1,0] neg_hi:[0,1,0]
    v_pk_fma_f32 v[114:115], v[46:47], v[16:17], v[114:115] op_sel_hi:[1,0,1] neg_lo:[0,1,0] neg_hi:[0,1,0]
    v_pk_mul_f32 v[112:113], v[112:113], v[18:19] op_sel_hi:[1,0]
    v_pk_mul_f32 v[114:115], v[114:115], v[18:19] op_sel_hi:[1,0]
    v_cvt_pk_bf16_f32 v112, v112, v113
    v_cvt_pk_bf16_f32 v113, v114, v115
    v_pk_fma_f32 v[120:121], v[44:45], v[24:25], v[120:121] op_sel_hi:[1,0,1] neg_lo:[0,1,0] neg_hi:[0,1,0]
    v_pk_fma_f32 v[122:123], v[46:47], v[24:25], v[122:123] op_sel_hi:[1,0,1] neg_lo:[0,1,0] neg_hi:[0,1,0]
    v_pk_mul_f32 v[120:121], v[120:121], v[26:27] op_sel_hi:[1,0]
    v_pk_mul_f32 v[122:123], v[122:123], v[26:27] op_sel_hi:[1,0]
    v_cvt_pk_bf16_f32 v114, v120, v121
    v_cvt_pk_bf16_f32 v115, v122, v123
    buffer_store_dwordx4 v[112:115], v58, s[16:19], s34 offen offset:0 sc1
    v_pk_fma_f32 v[116:117], v[44:45], v[20:21], v[116:117] op_sel_hi:[1,0,1] neg_lo:[0,1,0] neg_hi:[0,1,0]
    v_pk_fma_f32 v[118:119], v[46:47], v[20:21], v[118:119] op_sel_hi:[1,0,1] neg_lo:[0,1,0] neg_hi:[0,1,0]
    v_pk_mul_f32 v[116:117], v[116:117], v[22:23] op_sel_hi:[1,0]
    v_pk_mul_f32 v[118:119], v[118:119], v[22:23] op_sel_hi:[1,0]
    v_cvt_pk_bf16_f32 v116, v116, v117
    v_cvt_pk_bf16_f32 v117, v118, v119
    v_pk_fma_f32 v[124:125], v[44:45], v[28:29], v[124:125] op_sel_hi:[1,0,1] neg_lo:[0,1,0] neg_hi:[0,1,0]
    v_pk_fma_f32 v[126:127], v[46:47], v[28:29], v[126:127] op_sel_hi:[1,0,1] neg_lo:[0,1,0] neg_hi:[0,1,0]
    v_pk_mul_f32 v[124:125], v[124:125], v[30:31] op_sel_hi:[1,0]
    v_pk_mul_f32 v[126:127], v[126:127], v[30:31] op_sel_hi:[1,0]
    v_cvt_pk_bf16_f32 v118, v124, v125
    v_cvt_pk_bf16_f32 v119, v126, v127
    buffer_store_dwordx4 v[116:119], v58, s[16:19], s34 offen offset:128 sc1
    s_branch parallel_sum__softmax_full_mha__glu_gated_swiglu__prompt_kernel_pub
parallel_sum__softmax_full_mha__glu_gated_swiglu__prompt_kernel_vpath:
    s_sub_u32 s32, s11, 10
    s_lshl_b32 s32, s32, 2
    s_add_u32 s32, s32, s35
    s_lshl_b32 s32, s32, 9
    s_lshl_b32 s33, s10, 2
    s_lshl_b32 s3, s28, 1
    s_add_u32 s33, s33, s3
    s_mul_i32 s33, s33, 40960
    s_add_u32 s33, s33, 5242880
    v_mul_u32_u24 v58, 10240, v57
    v_lshl_add_u32 v58, v56, 4, v58
    v_lshrrev_b32 v59, 1, v57
    v_lshlrev_b32 v59, 6, v59
    v_lshl_add_u32 v59, v63, 4, v59
    s_lshl_b32 s3, s28, 8
    s_add_u32 s3, s3, 156160
    v_add_u32 v59, s3, v59
    v_xor_b32 v60, 128, v61
    s_mov_b32 s30, 10
.p2align 6
parallel_sum__softmax_full_mha__glu_gated_swiglu__prompt_kernel_loopv:
    s_waitcnt lgkmcnt(0)
    v_mfma_f32_16x16x32_bf16 v[64:67], v[16:19], v[32:35], v[64:67]
    s_add_u32 s38, s36, 32768
    s_cmp_eq_u32 s38, 98304
    s_cselect_b32 s38, 0, s38
    s_sub_u32 s37, s38, s36
    s_mov_b32 s36, s38
    ds_read_b64_tr_b16 v[144:145], v4 offset:8192
    v_mfma_f32_16x16x32_bf16 v[68:71], v[20:23], v[32:35], v[68:71]
    ds_read_b64_tr_b16 v[146:147], v4 offset:9216
    v_mfma_f32_16x16x32_bf16 v[72:75], v[24:27], v[32:35], v[72:75]
    ds_read_b128 v[128:131], v3 offset:0
    v_mfma_f32_16x16x32_bf16 v[76:79], v[28:31], v[32:35], v[76:79]
    ds_read_b128 v[132:135], v3 offset:1024
    v_mfma_f32_16x16x32_bf16 v[80:83], v[16:19], v[36:39], v[80:83]
    ds_read_b128 v[136:139], v3 offset:4096
    v_mfma_f32_16x16x32_bf16 v[84:87], v[20:23], v[36:39], v[84:87]
    ds_read_b128 v[140:143], v3 offset:5120
    v_mfma_f32_16x16x32_bf16 v[88:91], v[24:27], v[36:39], v[88:91]
    ds_read_b64_tr_b16 v[148:149], v5 offset:8192
    v_mfma_f32_16x16x32_bf16 v[92:95], v[28:31], v[36:39], v[92:95]
    ds_read_b64_tr_b16 v[150:151], v5 offset:9216
    v_mfma_f32_16x16x32_bf16 v[96:99], v[16:19], v[40:43], v[96:99]
    ds_read_b64_tr_b16 v[152:153], v6 offset:8192
    v_mfma_f32_16x16x32_bf16 v[100:103], v[20:23], v[40:43], v[100:103]
    ds_read_b64_tr_b16 v[154:155], v6 offset:9216
    v_mfma_f32_16x16x32_bf16 v[104:107], v[24:27], v[40:43], v[104:107]
    ds_read_b64_tr_b16 v[156:157], v7 offset:8192
    v_mfma_f32_16x16x32_bf16 v[108:111], v[28:31], v[40:43], v[108:111]
    ds_read_b64_tr_b16 v[158:159], v7 offset:9216
    v_mfma_f32_16x16x32_bf16 v[112:115], v[16:19], v[44:47], v[112:115]
    v_mfma_f32_16x16x32_bf16 v[116:119], v[20:23], v[44:47], v[116:119]
    v_mfma_f32_16x16x32_bf16 v[120:123], v[24:27], v[44:47], v[120:123]
    v_mfma_f32_16x16x32_bf16 v[124:127], v[28:31], v[44:47], v[124:127]
    v_mfma_f32_16x16x32_bf16 v[48:51], v[12:15], v[32:35], v[48:51]
    v_mfma_f32_16x16x32_bf16 v[52:55], v[12:15], v[36:39], v[52:55]
    s_cmp_eq_u32 s30, 1
    s_cbranch_scc1 parallel_sum__softmax_full_mha__glu_gated_swiglu__prompt_kernel_finv
    s_waitcnt lgkmcnt(0)
    v_mfma_f32_16x16x32_bf16 v[64:67], v[128:131], v[144:147], v[64:67]
    s_barrier
    v_add_u32 v4, s37, v4
    v_add_u32 v2, s37, v2
    v_add_u32 v3, s37, v3
    v_add_u32 v5, s37, v5
    v_add_u32 v6, s37, v6
    v_add_u32 v7, s37, v7
    ds_read_b64_tr_b16 v[32:33], v4 offset:0
    v_mfma_f32_16x16x32_bf16 v[68:71], v[132:135], v[144:147], v[68:71]
    ds_read_b64_tr_b16 v[34:35], v4 offset:1024
    v_mfma_f32_16x16x32_bf16 v[72:75], v[136:139], v[144:147], v[72:75]
    ds_read_b128 v[16:19], v2 offset:0
    v_mfma_f32_16x16x32_bf16 v[76:79], v[140:143], v[144:147], v[76:79]
    ds_read_b128 v[20:23], v2 offset:1024
    v_mfma_f32_16x16x32_bf16 v[80:83], v[128:131], v[148:151], v[80:83]
    ds_read_b128 v[24:27], v2 offset:4096
    v_mfma_f32_16x16x32_bf16 v[84:87], v[132:135], v[148:151], v[84:87]
    ds_read_b128 v[28:31], v2 offset:5120
    v_mfma_f32_16x16x32_bf16 v[88:91], v[136:139], v[148:151], v[88:91]
    ds_read_b64_tr_b16 v[36:37], v5 offset:0
    v_mfma_f32_16x16x32_bf16 v[92:95], v[140:143], v[148:151], v[92:95]
    ds_read_b64_tr_b16 v[38:39], v5 offset:1024
    v_mfma_f32_16x16x32_bf16 v[96:99], v[128:131], v[152:155], v[96:99]
    ds_read_b64_tr_b16 v[40:41], v6 offset:0
    v_mfma_f32_16x16x32_bf16 v[100:103], v[132:135], v[152:155], v[100:103]
    ds_read_b64_tr_b16 v[42:43], v6 offset:1024
    v_mfma_f32_16x16x32_bf16 v[104:107], v[136:139], v[152:155], v[104:107]
    ds_read_b64_tr_b16 v[44:45], v7 offset:0
    v_mfma_f32_16x16x32_bf16 v[108:111], v[140:143], v[152:155], v[108:111]
    ds_read_b64_tr_b16 v[46:47], v7 offset:1024
    v_mfma_f32_16x16x32_bf16 v[112:115], v[128:131], v[156:159], v[112:115]
    v_mfma_f32_16x16x32_bf16 v[116:119], v[132:135], v[156:159], v[116:119]
    v_mfma_f32_16x16x32_bf16 v[120:123], v[136:139], v[156:159], v[120:123]
    v_mfma_f32_16x16x32_bf16 v[124:127], v[140:143], v[156:159], v[124:127]
    v_mfma_f32_16x16x32_bf16 v[48:51], v[12:15], v[144:147], v[48:51]
    v_mfma_f32_16x16x32_bf16 v[52:55], v[12:15], v[148:151], v[52:55]
    s_sub_u32 s30, s30, 1
    s_branch parallel_sum__softmax_full_mha__glu_gated_swiglu__prompt_kernel_loopv
parallel_sum__softmax_full_mha__glu_gated_swiglu__prompt_kernel_finv:
    s_waitcnt lgkmcnt(0)
    v_mfma_f32_16x16x32_bf16 v[48:51], v[12:15], v[144:147], v[48:51]
    v_mfma_f32_16x16x32_bf16 v[52:55], v[12:15], v[148:151], v[52:55]
    v_mfma_f32_16x16x32_bf16 v[64:67], v[128:131], v[144:147], v[64:67]
    v_mfma_f32_16x16x32_bf16 v[68:71], v[132:135], v[144:147], v[68:71]
    v_mfma_f32_16x16x32_bf16 v[72:75], v[136:139], v[144:147], v[72:75]
    v_mfma_f32_16x16x32_bf16 v[76:79], v[140:143], v[144:147], v[76:79]
    v_mfma_f32_16x16x32_bf16 v[80:83], v[128:131], v[148:151], v[80:83]
    v_mfma_f32_16x16x32_bf16 v[84:87], v[132:135], v[148:151], v[84:87]
    v_mfma_f32_16x16x32_bf16 v[88:91], v[136:139], v[148:151], v[88:91]
    v_mfma_f32_16x16x32_bf16 v[92:95], v[140:143], v[148:151], v[92:95]
    ds_write_b32 v61, v48
    ds_write_b32 v61, v52 offset:64
    v_mfma_f32_16x16x32_bf16 v[96:99], v[128:131], v[152:155], v[96:99]
    v_mfma_f32_16x16x32_bf16 v[100:103], v[132:135], v[152:155], v[100:103]
    v_mfma_f32_16x16x32_bf16 v[104:107], v[136:139], v[152:155], v[104:107]
    s_waitcnt lgkmcnt(0)
    s_barrier
    v_mfma_f32_16x16x32_bf16 v[108:111], v[140:143], v[152:155], v[108:111]
    ds_read_b32 v6, v60
    ds_read_b32 v8, v60 offset:64
    ds_read_b128 v[16:19], v59 offset:0
    v_mfma_f32_16x16x32_bf16 v[112:115], v[128:131], v[156:159], v[112:115]
    ds_read_b128 v[32:35], v59 offset:512
    ds_read_b128 v[20:23], v59 offset:32
    ds_read_b128 v[36:39], v59 offset:544
    v_mfma_f32_16x16x32_bf16 v[116:119], v[132:135], v[156:159], v[116:119]
    ds_read_b128 v[24:27], v59 offset:128
    ds_read_b128 v[40:43], v59 offset:640
    ds_read_b128 v[28:31], v59 offset:160
    v_mfma_f32_16x16x32_bf16 v[120:123], v[136:139], v[156:159], v[120:123]
    ds_read_b128 v[44:47], v59 offset:672
    v_mov_b32 v2, v48
    v_mov_b32 v4, v52
    v_mfma_f32_16x16x32_bf16 v[124:127], v[140:143], v[156:159], v[124:127]
    s_waitcnt lgkmcnt(4)
    s_xor_b32 s34, s32, 0
    s_add_u32 s34, s34, s33
    v_pk_fma_f32 v[64:65], v[16:17], v[2:3], v[64:65] op_sel_hi:[1,0,1] neg_lo:[0,1,0] neg_hi:[0,1,0]
    v_pk_fma_f32 v[66:67], v[18:19], v[2:3], v[66:67] op_sel_hi:[1,0,1] neg_lo:[0,1,0] neg_hi:[0,1,0]
    v_pk_mul_f32 v[64:65], v[64:65], v[32:33]
    v_pk_mul_f32 v[66:67], v[66:67], v[34:35]
    v_cvt_pk_bf16_f32 v64, v64, v65
    v_cvt_pk_bf16_f32 v65, v66, v67
    v_pk_fma_f32 v[68:69], v[20:21], v[2:3], v[68:69] op_sel_hi:[1,0,1] neg_lo:[0,1,0] neg_hi:[0,1,0]
    v_pk_fma_f32 v[70:71], v[22:23], v[2:3], v[70:71] op_sel_hi:[1,0,1] neg_lo:[0,1,0] neg_hi:[0,1,0]
    v_pk_mul_f32 v[68:69], v[68:69], v[36:37]
    v_pk_mul_f32 v[70:71], v[70:71], v[38:39]
    v_cvt_pk_bf16_f32 v66, v68, v69
    v_cvt_pk_bf16_f32 v67, v70, v71
    buffer_store_dwordx4 v[64:67], v58, s[16:19], s34 offen sc1
    s_xor_b32 s34, s32, 256
    s_add_u32 s34, s34, s33
    v_pk_fma_f32 v[80:81], v[16:17], v[4:5], v[80:81] op_sel_hi:[1,0,1] neg_lo:[0,1,0] neg_hi:[0,1,0]
    v_pk_fma_f32 v[82:83], v[18:19], v[4:5], v[82:83] op_sel_hi:[1,0,1] neg_lo:[0,1,0] neg_hi:[0,1,0]
    v_pk_mul_f32 v[80:81], v[80:81], v[32:33]
    v_pk_mul_f32 v[82:83], v[82:83], v[34:35]
    v_cvt_pk_bf16_f32 v80, v80, v81
    v_cvt_pk_bf16_f32 v81, v82, v83
    v_pk_fma_f32 v[84:85], v[20:21], v[4:5], v[84:85] op_sel_hi:[1,0,1] neg_lo:[0,1,0] neg_hi:[0,1,0]
    v_pk_fma_f32 v[86:87], v[22:23], v[4:5], v[86:87] op_sel_hi:[1,0,1] neg_lo:[0,1,0] neg_hi:[0,1,0]
    v_pk_mul_f32 v[84:85], v[84:85], v[36:37]
    v_pk_mul_f32 v[86:87], v[86:87], v[38:39]
    v_cvt_pk_bf16_f32 v82, v84, v85
    v_cvt_pk_bf16_f32 v83, v86, v87
    buffer_store_dwordx4 v[80:83], v58, s[16:19], s34 offen sc1
    s_xor_b32 s34, s32, 512
    s_add_u32 s34, s34, s33
    v_pk_fma_f32 v[96:97], v[16:17], v[6:7], v[96:97] op_sel_hi:[1,0,1] neg_lo:[0,1,0] neg_hi:[0,1,0]
    v_pk_fma_f32 v[98:99], v[18:19], v[6:7], v[98:99] op_sel_hi:[1,0,1] neg_lo:[0,1,0] neg_hi:[0,1,0]
    v_pk_mul_f32 v[96:97], v[96:97], v[32:33]
    v_pk_mul_f32 v[98:99], v[98:99], v[34:35]
    v_cvt_pk_bf16_f32 v96, v96, v97
    v_cvt_pk_bf16_f32 v97, v98, v99
    v_pk_fma_f32 v[100:101], v[20:21], v[6:7], v[100:101] op_sel_hi:[1,0,1] neg_lo:[0,1,0] neg_hi:[0,1,0]
    v_pk_fma_f32 v[102:103], v[22:23], v[6:7], v[102:103] op_sel_hi:[1,0,1] neg_lo:[0,1,0] neg_hi:[0,1,0]
    v_pk_mul_f32 v[100:101], v[100:101], v[36:37]
    v_pk_mul_f32 v[102:103], v[102:103], v[38:39]
    v_cvt_pk_bf16_f32 v98, v100, v101
    v_cvt_pk_bf16_f32 v99, v102, v103
    buffer_store_dwordx4 v[96:99], v58, s[16:19], s34 offen sc1
    s_xor_b32 s34, s32, 768
    s_add_u32 s34, s34, s33
    v_pk_fma_f32 v[112:113], v[16:17], v[8:9], v[112:113] op_sel_hi:[1,0,1] neg_lo:[0,1,0] neg_hi:[0,1,0]
    v_pk_fma_f32 v[114:115], v[18:19], v[8:9], v[114:115] op_sel_hi:[1,0,1] neg_lo:[0,1,0] neg_hi:[0,1,0]
    v_pk_mul_f32 v[112:113], v[112:113], v[32:33]
    v_pk_mul_f32 v[114:115], v[114:115], v[34:35]
    v_cvt_pk_bf16_f32 v112, v112, v113
    v_cvt_pk_bf16_f32 v113, v114, v115
    v_pk_fma_f32 v[116:117], v[20:21], v[8:9], v[116:117] op_sel_hi:[1,0,1] neg_lo:[0,1,0] neg_hi:[0,1,0]
    v_pk_fma_f32 v[118:119], v[22:23], v[8:9], v[118:119] op_sel_hi:[1,0,1] neg_lo:[0,1,0] neg_hi:[0,1,0]
    v_pk_mul_f32 v[116:117], v[116:117], v[36:37]
    v_pk_mul_f32 v[118:119], v[118:119], v[38:39]
    v_cvt_pk_bf16_f32 v114, v116, v117
    v_cvt_pk_bf16_f32 v115, v118, v119
    buffer_store_dwordx4 v[112:115], v58, s[16:19], s34 offen sc1
    s_add_u32 s33, s33, 40960
    s_waitcnt lgkmcnt(0)
    s_xor_b32 s34, s32, 0
    s_add_u32 s34, s34, s33
    v_pk_fma_f32 v[72:73], v[24:25], v[2:3], v[72:73] op_sel_hi:[1,0,1] neg_lo:[0,1,0] neg_hi:[0,1,0]
    v_pk_fma_f32 v[74:75], v[26:27], v[2:3], v[74:75] op_sel_hi:[1,0,1] neg_lo:[0,1,0] neg_hi:[0,1,0]
    v_pk_mul_f32 v[72:73], v[72:73], v[40:41]
    v_pk_mul_f32 v[74:75], v[74:75], v[42:43]
    v_cvt_pk_bf16_f32 v72, v72, v73
    v_cvt_pk_bf16_f32 v73, v74, v75
    v_pk_fma_f32 v[76:77], v[28:29], v[2:3], v[76:77] op_sel_hi:[1,0,1] neg_lo:[0,1,0] neg_hi:[0,1,0]
    v_pk_fma_f32 v[78:79], v[30:31], v[2:3], v[78:79] op_sel_hi:[1,0,1] neg_lo:[0,1,0] neg_hi:[0,1,0]
    v_pk_mul_f32 v[76:77], v[76:77], v[44:45]
    v_pk_mul_f32 v[78:79], v[78:79], v[46:47]
    v_cvt_pk_bf16_f32 v74, v76, v77
    v_cvt_pk_bf16_f32 v75, v78, v79
    buffer_store_dwordx4 v[72:75], v58, s[16:19], s34 offen sc1
    s_xor_b32 s34, s32, 256
    s_add_u32 s34, s34, s33
    v_pk_fma_f32 v[88:89], v[24:25], v[4:5], v[88:89] op_sel_hi:[1,0,1] neg_lo:[0,1,0] neg_hi:[0,1,0]
    v_pk_fma_f32 v[90:91], v[26:27], v[4:5], v[90:91] op_sel_hi:[1,0,1] neg_lo:[0,1,0] neg_hi:[0,1,0]
    v_pk_mul_f32 v[88:89], v[88:89], v[40:41]
    v_pk_mul_f32 v[90:91], v[90:91], v[42:43]
    v_cvt_pk_bf16_f32 v88, v88, v89
    v_cvt_pk_bf16_f32 v89, v90, v91
    v_pk_fma_f32 v[92:93], v[28:29], v[4:5], v[92:93] op_sel_hi:[1,0,1] neg_lo:[0,1,0] neg_hi:[0,1,0]
    v_pk_fma_f32 v[94:95], v[30:31], v[4:5], v[94:95] op_sel_hi:[1,0,1] neg_lo:[0,1,0] neg_hi:[0,1,0]
    v_pk_mul_f32 v[92:93], v[92:93], v[44:45]
    v_pk_mul_f32 v[94:95], v[94:95], v[46:47]
    v_cvt_pk_bf16_f32 v90, v92, v93
    v_cvt_pk_bf16_f32 v91, v94, v95
    buffer_store_dwordx4 v[88:91], v58, s[16:19], s34 offen sc1
    s_xor_b32 s34, s32, 512
    s_add_u32 s34, s34, s33
    v_pk_fma_f32 v[104:105], v[24:25], v[6:7], v[104:105] op_sel_hi:[1,0,1] neg_lo:[0,1,0] neg_hi:[0,1,0]
    v_pk_fma_f32 v[106:107], v[26:27], v[6:7], v[106:107] op_sel_hi:[1,0,1] neg_lo:[0,1,0] neg_hi:[0,1,0]
    v_pk_mul_f32 v[104:105], v[104:105], v[40:41]
    v_pk_mul_f32 v[106:107], v[106:107], v[42:43]
    v_cvt_pk_bf16_f32 v104, v104, v105
    v_cvt_pk_bf16_f32 v105, v106, v107
    v_pk_fma_f32 v[108:109], v[28:29], v[6:7], v[108:109] op_sel_hi:[1,0,1] neg_lo:[0,1,0] neg_hi:[0,1,0]
    v_pk_fma_f32 v[110:111], v[30:31], v[6:7], v[110:111] op_sel_hi:[1,0,1] neg_lo:[0,1,0] neg_hi:[0,1,0]
    v_pk_mul_f32 v[108:109], v[108:109], v[44:45]
    v_pk_mul_f32 v[110:111], v[110:111], v[46:47]
    v_cvt_pk_bf16_f32 v106, v108, v109
    v_cvt_pk_bf16_f32 v107, v110, v111
    buffer_store_dwordx4 v[104:107], v58, s[16:19], s34 offen sc1
    s_xor_b32 s34, s32, 768
    s_add_u32 s34, s34, s33
    v_pk_fma_f32 v[120:121], v[24:25], v[8:9], v[120:121] op_sel_hi:[1,0,1] neg_lo:[0,1,0] neg_hi:[0,1,0]
    v_pk_fma_f32 v[122:123], v[26:27], v[8:9], v[122:123] op_sel_hi:[1,0,1] neg_lo:[0,1,0] neg_hi:[0,1,0]
    v_pk_mul_f32 v[120:121], v[120:121], v[40:41]
    v_pk_mul_f32 v[122:123], v[122:123], v[42:43]
    v_cvt_pk_bf16_f32 v120, v120, v121
    v_cvt_pk_bf16_f32 v121, v122, v123
    v_pk_fma_f32 v[124:125], v[28:29], v[8:9], v[124:125] op_sel_hi:[1,0,1] neg_lo:[0,1,0] neg_hi:[0,1,0]
    v_pk_fma_f32 v[126:127], v[30:31], v[8:9], v[126:127] op_sel_hi:[1,0,1] neg_lo:[0,1,0] neg_hi:[0,1,0]
    v_pk_mul_f32 v[124:125], v[124:125], v[44:45]
    v_pk_mul_f32 v[126:127], v[126:127], v[46:47]
    v_cvt_pk_bf16_f32 v122, v124, v125
    v_cvt_pk_bf16_f32 v123, v126, v127
    buffer_store_dwordx4 v[120:123], v58, s[16:19], s34 offen sc1
parallel_sum__softmax_full_mha__glu_gated_swiglu__prompt_kernel_pub:
    s_barrier
    v_mov_b32 v2, 155900
    ds_read_b32 v2, v2
    s_waitcnt lgkmcnt(0)
    v_readfirstlane_b32 s99, v2
    s_lshl_b32 s3, s11, 4
    s_add_u32 s3, s3, s10
    s_lshl_b32 s3, s3, 4
    s_add_u32 s39, s3, 24920064
    s_waitcnt vmcnt(0)
    s_mov_b64 exec, 1
    v_mov_b32 v2, 155920
    v_mov_b32 v3, 1
    ds_add_rtn_u32 v3, v2, v3
    v_mov_b32 v2, 0
    v_mov_b32 v4, s99
    s_waitcnt lgkmcnt(0)
    v_cmp_eq_u32 vcc, 3, v3
    s_cbranch_vccz parallel_sum__softmax_full_mha__glu_gated_swiglu__prompt_kernel_sg2
    buffer_store_dword v4, v2, s[16:19], s39 offen sc1
parallel_sum__softmax_full_mha__glu_gated_swiglu__prompt_kernel_sg2:
    s_mov_b64 exec, -1
    s_branch parallel_sum__softmax_full_mha__glu_gated_swiglu__prompt_kernel_att
parallel_sum__softmax_full_mha__glu_gated_swiglu__prompt_kernel_mpf:
    s_load_dwordx4 s[40:43], s[0:1], 32
    s_load_dwordx2 s[44:45], s[0:1], 48
    s_load_dwordx2 s[46:47], s[0:1], 16
    s_lshl_b32 s3, s10, 2
    s_add_u32 s3, s3, s12
    s_lshl_b32 s31, s3, 10
    v_lshlrev_b32 v2, 4, v0
    s_waitcnt lgkmcnt(0)
    s_mov_b32 s20, s40
    s_and_b32 s21, s41, 0xffff
    s_mov_b32 s22, 1966080
    s_mov_b32 s23, 0x00020000
    s_mov_b32 s24, s42
    s_and_b32 s25, s43, 0xffff
    s_mov_b32 s26, 1966080
    s_mov_b32 s27, 0x00020000
    s_mov_b32 s48, s44
    s_and_b32 s49, s45, 0xffff
    s_mov_b32 s50, 1966080
    s_mov_b32 s51, 0x00020000
    s_mov_b32 s52, s46
    s_and_b32 s53, s47, 0xffff
    s_mov_b32 s54, 819200
    s_mov_b32 s55, 0x00020000
    s_barrier
    s_barrier
    s_barrier
    s_barrier
    s_mov_b32 s3, s31
    s_mov_b32 s30, 0
parallel_sum__softmax_full_mha__glu_gated_swiglu__prompt_kernel_pl1:
    buffer_load_dwordx4 v[64:67], v2, s[20:23], s3 offen
    buffer_load_dwordx4 v[68:71], v2, s[24:27], s3 offen
    s_add_u32 s3, s3, 65536
    buffer_load_dwordx4 v[72:75], v2, s[20:23], s3 offen
    buffer_load_dwordx4 v[76:79], v2, s[24:27], s3 offen
    s_add_u32 s3, s3, 65536
    s_cmp_ge_u32 s30, 0
    s_cbranch_scc1 parallel_sum__softmax_full_mha__glu_gated_swiglu__prompt_kernel_pl2
parallel_sum__softmax_full_mha__glu_gated_swiglu__prompt_kernel_pl2:
    s_add_u32 s30, s30, 1
    s_cmp_lg_u32 s30, 10
    s_cbranch_scc1 parallel_sum__softmax_full_mha__glu_gated_swiglu__prompt_kernel_pl1
    s_barrier
    s_barrier
    s_barrier
    s_barrier
    s_barrier
    s_barrier
    s_barrier
    s_barrier
    s_waitcnt vmcnt(0)
    v_mov_b32 v2, 155900
    ds_read_b32 v2, v2
    s_waitcnt lgkmcnt(0)
    v_readfirstlane_b32 s99, v2
parallel_sum__softmax_full_mha__glu_gated_swiglu__prompt_kernel_att:
    s_setprio 2
    s_and_b32 s3, s2, 7
    s_lshl_b32 s3, s3, 2
    s_bfe_u32 s10, s2, 0x20003
    s_add_u32 s10, s10, s3
    s_lshr_b32 s11, s2, 5
    s_lshr_b32 s3, s10, 1
    s_mul_i32 s3, s3, 5
    s_and_b32 s13, s10, 1
    s_mul_i32 s14, s13, 3
    s_add_u32 s20, s3, s14
    s_add_u32 s21, s20, 1
    s_add_u32 s22, s3, 2
    s_lshl_b32 s20, s20, 15
    s_lshl_b32 s21, s21, 15
    s_lshl_b32 s22, s22, 15
    s_and_b32 s24, s12, 3
    s_lshr_b32 s25, s12, 2
    s_cmp_eq_u32 s24, 0
    s_cselect_b32 s32, s20, s21
    s_cmp_eq_u32 s24, 2
    s_cselect_b32 s32, s22, s32
    s_lshl_b32 s3, s25, 14
    s_add_u32 s32, s32, s3
    s_add_u32 s32, s32, 2621440
    s_lshl_b32 s3, s25, 6
    s_add_u32 s3, s3, s24
    s_mul_i32 s3, s3, 20480
    s_mul_i32 s33, s10, 320
    s_add_u32 s33, s33, s3
    s_add_u32 s33, s33, 5242880
    s_lshl_b32 s34, s25, 13
    s_lshl_b32 s3, s24, 10
    s_add_u32 s34, s34, s3
    s_mul_i32 s35, s11, 0
    s_and_b32 s35, s35, 0x3fff
    v_lshlrev_b32 v136, 4, v0
    v_lshrrev_b32 v7, 5, v0
    v_mul_u32_u24 v137, 10240, v7
    v_and_b32 v1, 31, v0
    v_lshl_add_u32 v137, v1, 4, v137
    s_lshl_b32 s28, s11, 3
    s_lshl_b32 s3, s24, 1
    s_add_u32 s28, s28, s3
    s_add_u32 s28, s28, s25
    v_lshlrev_b32 v6, 3, v0
    v_lshrrev_b32 v76, 4, v0
    v_lshlrev_b32 v76, 9, v76
    v_and_b32 v77, 15, v0
    v_min_u32 v77, 11, v77
    v_lshl_add_u32 v76, v77, 4, v76
    s_lshr_b32 s3, s12, 1
    s_lshl_b32 s3, s3, 13
    s_and_b32 s36, s12, 1
    s_lshl_b32 s36, s36, 11
    s_add_u32 s3, s3, s36
    v_add_u32 v76, s3, v76
    v_cmp_eq_u32 vcc, 0, v77
    v_mov_b32 v78, 0x3f803f80
    s_nop 0
    v_cndmask_b32 v72, 0, v78, vcc
    v_mov_b32 v73, v72
    v_mov_b32 v74, v72
    v_mov_b32 v75, v72
    ds_write_b128 v76, v[72:75] offset:3392
    s_lshr_b32 s3, s12, 1
    s_lshl_b32 s3, s3, 13
    v_mov_b32 v79, s3
    v_mov_b32 v80, 0x3f803f80
    v_mov_b32 v81, 0x3f80
    v_mov_b32 v82, 0x3f803f80
    v_mov_b32 v83, 0x3f80
    ds_write_b128 v79, v[80:83] offset:7168
    s_lshl_b32 s3, s25, 13
    v_add_u32 v3, s3, v136
    s_add_u32 s3, s3, 5120
    v_mov_b32 v2, s3
    v_cmp_eq_u32 vcc, s13, v7
    s_nop 1
    v_cndmask_b32 v2, v2, v3, vcc
    v_mov_b32 v138, 0
    s_lshl_b32 s3, s12, 2
    s_add_u32 s3, s3, 155840
    v_mov_b32 v139, s3
    v_and_b32 v140, 7, v0
    v_lshlrev_b32 v140, 2, v140
    v_add_u32 v140, 155840, v140
    v_mov_b32 v142, 32
    v_mov_b32 v143, 155892
    s_mov_b32 s26, 0
    s_cmp_lg_u32 s12, 0
    s_cbranch_scc1 parallel_sum__softmax_full_mha__glu_gated_swiglu__prompt_kernel_pq_r
    s_lshr_b32 s3, s10, 1
    s_mul_i32 s3, s3, 40
    s_lshr_b32 s29, s3, 7
    s_add_u32 s30, s3, 39
    s_lshr_b32 s30, s30, 7
    s_sub_u32 s30, s30, s29
    s_lshl_b32 s30, s30, 8
    s_lshl_b32 s29, s29, 8
    s_add_u32 s29, s29, 24920064
    v_and_b32 v88, 15, v0
    v_lshlrev_b32 v88, 4, v88
    v_bfe_u32 v89, v0, 4, 1
    v_mul_u32_u24 v89, s30, v89
    v_add_u32 v88, v88, v89
    v_mul_u32_u24 v89, 1280, v7
    v_add_u32 v89, v88, v89
    s_mov_b32 s31, 0x100000
parallel_sum__softmax_full_mha__glu_gated_swiglu__prompt_kernel_pq_l:
    buffer_load_dword v92, v89, s[16:19], s29 offen offset:1280 sc1
    buffer_load_dword v93, v88, s[16:19], s29 offen sc1
    s_sub_u32 s31, s31, 1
    s_cmp_eq_u32 s31, 0
    s_cbranch_scc1 parallel_sum__softmax_full_mha__glu_gated_swiglu__prompt_kernel_pq_r
    s_waitcnt vmcnt(0)
    v_xor_b32 v92, s99, v92
    v_xor_b32 v93, s99, v93
    v_or_b32 v92, v92, v93
    v_cmp_ne_u32 vcc, 0, v92
    s_cbranch_vccz parallel_sum__softmax_full_mha__glu_gated_swiglu__prompt_kernel_pq_r
    s_sleep 2
    s_branch parallel_sum__softmax_full_mha__glu_gated_swiglu__prompt_kernel_pq_l
parallel_sum__softmax_full_mha__glu_gated_swiglu__prompt_kernel_pq_r:
    v_add_u32 v138, 1, v138
    ds_write_b32 v139, v138
    ds_read_b32 v141, v140
    s_waitcnt lgkmcnt(0)
    v_cmp_lt_u32 vcc, v141, v138
    s_cbranch_vccnz parallel_sum__softmax_full_mha__glu_gated_swiglu__prompt_kernel_sb0s
parallel_sum__softmax_full_mha__glu_gated_swiglu__prompt_kernel_sb0r:
    ds_write_b32 v143, v142 offset:12
    s_mul_i32 s36, s35, 80
    s_add_u32 s36, s36, s33
    s_add_u32 m0, s34, 3072
    s_mov_b32 exec_lo, 0x000fffff
    s_mov_b32 exec_hi, 0x000fffff
    buffer_load_dwordx4 v137, s[16:19], s36 offen sc1 lds
    s_mov_b64 exec, -1
    s_cmp_eq_u32 s24, 3
    s_cbranch_scc1 parallel_sum__softmax_full_mha__glu_gated_swiglu__prompt_kernel_kv0
    s_mov_b32 m0, s34
    s_add_u32 s36, s32, s35
    buffer_load_dwordx4 v136, s[16:19], s36 offen sc1 lds
parallel_sum__softmax_full_mha__glu_gated_swiglu__prompt_kernel_kv0:
    s_xor_b32 s34, s34, 16384
    s_add_u32 s35, s35, 1024
    s_and_b32 s35, s35, 0x3fff
    s_xor_b32 s3, s28, 0
    s_and_b32 s29, s3, 1
    s_lshl_b32 s29, s29, 3
    s_lshr_b32 s3, s3, 1
    s_lshl_b32 s3, s3, 10
    s_add_u32 s3, s3, s29
    s_add_u32 s29, s3, s20
    s_add_u32 s30, s3, s21
    s_add_u32 s31, s3, s22
    buffer_load_dwordx2 v[8:9], v136, s[16:19], s29 offen sc1
    buffer_load_dwordx2 v[10:11], v136, s[16:19], s30 offen sc1
    buffer_load_dwordx2 v[12:13], v136, s[16:19], s31 offen sc1
    s_xor_b32 s3, s28, 1
    s_and_b32 s29, s3, 1
    s_lshl_b32 s29, s29, 3
    s_lshr_b32 s3, s3, 1
    s_lshl_b32 s3, s3, 10
    s_add_u32 s3, s3, s29
    s_add_u32 s29, s3, s20
    s_add_u32 s30, s3, s21
    s_add_u32 s31, s3, s22
    buffer_load_dwordx2 v[16:17], v136, s[16:19], s29 offen sc1
    buffer_load_dwordx2 v[18:19], v136, s[16:19], s30 offen sc1
    buffer_load_dwordx2 v[20:21], v136, s[16:19], s31 offen sc1
    s_setprio 2
    s_waitcnt vmcnt(0) lgkmcnt(0)
    v_add_u32 v138, 1, v138
    ds_write_b32 v139, v138
    ds_read_b32 v141, v140
    s_waitcnt lgkmcnt(0)
    v_cmp_lt_u32 vcc, v141, v138
    s_cbranch_vccnz parallel_sum__softmax_full_mha__glu_gated_swiglu__prompt_kernel_sb1s
parallel_sum__softmax_full_mha__glu_gated_swiglu__prompt_kernel_sb1r:
    v_mov_b32 v1, 33
    ds_write_b32 v143, v1 offset:12
    ds_read2_b64 v[24:27], v3 offset0:0 offset1:128
    ds_read_b64 v[28:29], v2 offset:2048
    s_mul_i32 s36, s35, 80
    s_add_u32 s36, s36, s33
    s_add_u32 m0, s34, 3072
    s_mov_b32 exec_lo, 0x000fffff
    s_mov_b32 exec_hi, 0x000fffff
    buffer_load_dwordx4 v137, s[16:19], s36 offen sc1 lds
    s_mov_b64 exec, -1
    s_cmp_eq_u32 s24, 3
    s_cbranch_scc1 parallel_sum__softmax_full_mha__glu_gated_swiglu__prompt_kernel_kv1
    s_mov_b32 m0, s34
    s_add_u32 s36, s32, s35
    buffer_load_dwordx4 v136, s[16:19], s36 offen sc1 lds
parallel_sum__softmax_full_mha__glu_gated_swiglu__prompt_kernel_kv1:
    s_xor_b32 s34, s34, 16384
    s_add_u32 s35, s35, 1024
    s_and_b32 s35, s35, 0x3fff
    v_cmp_eq_u32 vcc, s13, v7
    s_nop 1
    v_cndmask_b32 v12, 0, v12, vcc
    v_cndmask_b32 v13, 0, v13, vcc
    v_cndmask_b32 v20, 0, v20, vcc
    v_cndmask_b32 v21, 0, v21, vcc
    s_waitcnt lgkmcnt(0)
    v_mfma_f32_32x32x8_bf16 v[72:87], v[28:29], v[12:13], 0
    v_mfma_f32_32x32x16_bf16 v[72:87], v[24:27], v[8:11], v[72:87]
    v_mfma_f32_32x32x8_bf16 v[88:103], v[28:29], v[20:21], 0
    v_mfma_f32_32x32x16_bf16 v[88:103], v[24:27], v[16:19], v[88:103]
    v_mov_b32 v104, 0
    v_mov_b32 v120, 0
    v_mov_b32 v105, 0
    v_mov_b32 v121, 0
    v_mov_b32 v106, 0
    v_mov_b32 v122, 0
    v_mov_b32 v107, 0
    v_mov_b32 v123, 0
    v_mov_b32 v108, 0
    v_mov_b32 v124, 0
    v_mov_b32 v109, 0
    v_mov_b32 v125, 0
    v_mov_b32 v110, 0
    v_mov_b32 v126, 0
    v_mov_b32 v111, 0
    v_mov_b32 v127, 0
    v_mov_b32 v112, 0
    v_mov_b32 v128, 0
    v_mov_b32 v113, 0
    v_mov_b32 v129, 0
    v_mov_b32 v114, 0
    v_mov_b32 v130, 0
    v_mov_b32 v115, 0
    v_mov_b32 v131, 0
    v_mov_b32 v116, 0
    v_mov_b32 v132, 0
    v_mov_b32 v117, 0
    v_mov_b32 v133, 0
    v_mov_b32 v118, 0
    v_mov_b32 v134, 0
    v_mov_b32 v119, 0
    v_mov_b32 v135, 0
    v_max3_f32 v4, v72, v73, v74
    v_max3_f32 v4, v4, v75, v76
    v_max3_f32 v4, v4, v77, v78
    v_max3_f32 v4, v4, v79, v80
    v_max3_f32 v4, v4, v81, v82
    v_max3_f32 v4, v4, v83, v84
    v_max3_f32 v4, v4, v85, v86
    v_max_f32 v4, v4, v87
    v_max3_f32 v5, v88, v89, v90
    v_max3_f32 v5, v5, v91, v92
    v_max3_f32 v5, v5, v93, v94
    v_max3_f32 v5, v5, v95, v96
    v_max3_f32 v5, v5, v97, v98
    v_max3_f32 v5, v5, v99, v100
    v_max3_f32 v5, v5, v101, v102
    v_max_f32 v5, v5, v103
    v_cmp_eq_u32 vcc, s13, v7
    v_mov_b32 v1, v4
    s_nop 1
    v_permlane32_swap_b32 v4, v1
    v_max_f32 v4, v4, v1
    v_sub_f32 v1, 0, v4
    v_and_b32 v6, 0xffff0000, v1
    v_sub_f32 v1, v1, v6
    v_and_b32 v56, 0xffff0000, v1
    v_sub_f32 v1, v1, v56
    v_lshrrev_b32 v6, 16, v6
    v_or_b32 v6, v6, v56
    v_lshrrev_b32 v1, 16, v1
    v_cndmask_b32 v12, v6, v12, vcc
    v_cndmask_b32 v13, v1, v13, vcc
    v_mov_b32 v1, v5
    s_nop 1
    v_permlane32_swap_b32 v5, v1
    v_max_f32 v5, v5, v1
    v_sub_f32 v1, 0, v5
    v_and_b32 v6, 0xffff0000, v1
    v_sub_f32 v1, v1, v6
    v_and_b32 v56, 0xffff0000, v1
    v_sub_f32 v1, v1, v56
    v_lshrrev_b32 v6, 16, v6
    v_or_b32 v6, v6, v56
    v_lshrrev_b32 v1, 16, v1
    v_cndmask_b32 v20, v6, v20, vcc
    v_cndmask_b32 v21, v1, v21, vcc
parallel_sum__softmax_full_mha__glu_gated_swiglu__prompt_kernel_restart:
    ds_read2_b64 v[32:35], v3 offset0:1 offset1:129
    ds_read_b64 v[36:37], v2 offset:2056
    ds_read_b128 v[40:43], v3 offset:3072
    ds_read_b128 v[44:47], v3 offset:4096
    v_mfma_f32_32x32x8_bf16 v[72:87], v[28:29], v[12:13], 0
    v_mfma_f32_32x32x16_bf16 v[72:87], v[24:27], v[8:11], v[72:87]
    v_mov_b32 v64, 0
    v_mov_b32 v48, 0
    v_mov_b32 v65, 0
    v_mov_b32 v49, 0
    v_mov_b32 v66, 0
    v_mov_b32 v50, 0
    v_mov_b32 v67, 0
    v_mov_b32 v51, 0
    v_mov_b32 v68, 0
    v_mov_b32 v52, 0
    v_mov_b32 v69, 0
    v_mov_b32 v53, 0
    v_mov_b32 v70, 0
    v_mov_b32 v54, 0
    v_mov_b32 v71, 0
    v_mov_b32 v55, 0
    s_mov_b32 s27, 16
.p2align 6
parallel_sum__softmax_full_mha__glu_gated_swiglu__prompt_kernel_loop:
    v_mfma_f32_32x32x8_bf16 v[88:103], v[28:29], v[20:21], 0
    v_exp_f32 v72, v72
    v_exp_f32 v73, v73
    v_exp_f32 v74, v74
    v_exp_f32 v75, v75
    v_cvt_pk_bf16_f32 v56, v72, v73
    v_cvt_pk_bf16_f32 v57, v74, v75
    v_mfma_f32_32x32x16_bf16 v[88:103], v[24:27], v[16:19], v[88:103]
    v_exp_f32 v76, v76
    v_exp_f32 v77, v77
    v_exp_f32 v78, v78
    v_exp_f32 v79, v79
    v_cvt_pk_bf16_f32 v58, v76, v77
    v_cvt_pk_bf16_f32 v59, v78, v79
    v_mfma_f32_32x32x16_bf16 v[120:135], v[48:51], v[64:67], v[120:135]
    v_exp_f32 v80, v80
    v_exp_f32 v81, v81
    v_exp_f32 v82, v82
    v_exp_f32 v83, v83
    v_cvt_pk_bf16_f32 v60, v80, v81
    v_cvt_pk_bf16_f32 v61, v82, v83
    v_mfma_f32_32x32x16_bf16 v[120:135], v[52:55], v[68:71], v[120:135]
    v_exp_f32 v84, v84
    v_exp_f32 v85, v85
    v_exp_f32 v86, v86
    v_exp_f32 v87, v87
    v_cvt_pk_bf16_f32 v62, v84, v85
    v_cvt_pk_bf16_f32 v63, v86, v87
    s_waitcnt lgkmcnt(0)
    v_mfma_f32_32x32x8_bf16 v[72:87], v[36:37], v[12:13], 0
    ds_read_b128 v[48:51], v3 offset:5120
    ds_read_b128 v[52:55], v3 offset:6144
    v_exp_f32 v88, v88
    v_exp_f32 v89, v89
    v_exp_f32 v90, v90
    v_exp_f32 v91, v91
    v_cvt_pk_bf16_f32 v64, v88, v89
    v_cvt_pk_bf16_f32 v65, v90, v91
    s_setprio 1
    v_mfma_f32_32x32x16_bf16 v[72:87], v[32:35], v[8:11], v[72:87]
    v_exp_f32 v92, v92
    v_exp_f32 v93, v93
    v_exp_f32 v94, v94
    v_exp_f32 v95, v95
    v_cvt_pk_bf16_f32 v66, v92, v93
    v_cvt_pk_bf16_f32 v67, v94, v95
    v_mfma_f32_32x32x16_bf16 v[104:119], v[40:43], v[56:59], v[104:119]
    v_exp_f32 v96, v96
    v_exp_f32 v97, v97
    v_exp_f32 v98, v98
    v_exp_f32 v99, v99
    v_cvt_pk_bf16_f32 v68, v96, v97
    v_cvt_pk_bf16_f32 v69, v98, v99
    v_mfma_f32_32x32x16_bf16 v[104:119], v[44:47], v[60:63], v[104:119]
    v_exp_f32 v100, v100
    v_exp_f32 v101, v101
    v_exp_f32 v102, v102
    v_exp_f32 v103, v103
    v_cvt_pk_bf16_f32 v70, v100, v101
    v_cvt_pk_bf16_f32 v71, v102, v103
    s_waitcnt vmcnt(0) lgkmcnt(0)
    s_barrier
    s_setprio 2
    v_xor_b32 v3, 16384, v3
    v_xor_b32 v2, 16384, v2
    v_mfma_f32_32x32x8_bf16 v[88:103], v[36:37], v[20:21], 0
    ds_read2_b64 v[24:27], v3 offset0:0 offset1:128
    ds_read_b64 v[28:29], v2 offset:2048
    v_exp_f32 v72, v72
    v_exp_f32 v73, v73
    v_exp_f32 v74, v74
    v_exp_f32 v75, v75
    v_cvt_pk_bf16_f32 v56, v72, v73
    v_cvt_pk_bf16_f32 v57, v74, v75
    v_mfma_f32_32x32x16_bf16 v[88:103], v[32:35], v[16:19], v[88:103]
    s_cmp_le_u32 s27, 2
    s_cbranch_scc1 parallel_sum__softmax_full_mha__glu_gated_swiglu__prompt_kernel_nokv
    s_mul_i32 s36, s35, 80
    s_add_u32 s36, s36, s33
    s_add_u32 m0, s34, 3072
    s_mov_b32 exec_lo, 0x000fffff
    s_mov_b32 exec_hi, 0x000fffff
    buffer_load_dwordx4 v137, s[16:19], s36 offen sc1 lds
    s_mov_b64 exec, -1
    s_cmp_eq_u32 s24, 3
    s_cbranch_scc1 parallel_sum__softmax_full_mha__glu_gated_swiglu__prompt_kernel_kv2
    s_mov_b32 m0, s34
    s_add_u32 s36, s32, s35
    buffer_load_dwordx4 v136, s[16:19], s36 offen sc1 lds
parallel_sum__softmax_full_mha__glu_gated_swiglu__prompt_kernel_kv2:
    s_xor_b32 s34, s34, 16384
    s_add_u32 s35, s35, 1024
    s_and_b32 s35, s35, 0x3fff
parallel_sum__softmax_full_mha__glu_gated_swiglu__prompt_kernel_nokv:
    v_exp_f32 v76, v76
    v_exp_f32 v77, v77
    v_exp_f32 v78, v78
    v_exp_f32 v79, v79
    v_cvt_pk_bf16_f32 v58, v76, v77
    v_cvt_pk_bf16_f32 v59, v78, v79
    v_mfma_f32_32x32x16_bf16 v[120:135], v[40:43], v[64:67], v[120:135]
    v_exp_f32 v80, v80
    v_exp_f32 v81, v81
    v_exp_f32 v82, v82
    v_exp_f32 v83, v83
    v_cvt_pk_bf16_f32 v60, v80, v81
    v_cvt_pk_bf16_f32 v61, v82, v83
    v_mfma_f32_32x32x16_bf16 v[120:135], v[44:47], v[68:71], v[120:135]
    v_exp_f32 v84, v84
    v_exp_f32 v85, v85
    v_exp_f32 v86, v86
    v_exp_f32 v87, v87
    v_cvt_pk_bf16_f32 v62, v84, v85
    v_cvt_pk_bf16_f32 v63, v86, v87
    s_waitcnt lgkmcnt(0)
    v_mfma_f32_32x32x8_bf16 v[72:87], v[28:29], v[12:13], 0
    ds_read2_b64 v[32:35], v3 offset0:1 offset1:129
    ds_read_b64 v[36:37], v2 offset:2056
    v_exp_f32 v88, v88
    v_exp_f32 v89, v89
    v_exp_f32 v90, v90
    v_exp_f32 v91, v91
    v_cvt_pk_bf16_f32 v64, v88, v89
    v_cvt_pk_bf16_f32 v65, v90, v91
    v_mfma_f32_32x32x16_bf16 v[72:87], v[24:27], v[8:11], v[72:87]
    ds_read_b128 v[40:43], v3 offset:3072
    ds_read_b128 v[44:47], v3 offset:4096
    v_exp_f32 v92, v92
    v_exp_f32 v93, v93
    v_exp_f32 v94, v94
    v_exp_f32 v95, v95
    v_cvt_pk_bf16_f32 v66, v92, v93
    v_cvt_pk_bf16_f32 v67, v94, v95
    v_mfma_f32_32x32x16_bf16 v[104:119], v[48:51], v[56:59], v[104:119]
    v_exp_f32 v96, v96
    v_exp_f32 v97, v97
    v_exp_f32 v98, v98
    v_exp_f32 v99, v99
    v_cvt_pk_bf16_f32 v68, v96, v97
    v_cvt_pk_bf16_f32 v69, v98, v99
    v_mfma_f32_32x32x16_bf16 v[104:119], v[52:55], v[60:63], v[104:119]
    v_exp_f32 v100, v100
    v_exp_f32 v101, v101
    v_exp_f32 v102, v102
    v_exp_f32 v103, v103
    v_cvt_pk_bf16_f32 v70, v100, v101
    v_cvt_pk_bf16_f32 v71, v102, v103
    s_sub_u32 s27, s27, 1
    s_cmp_lg_u32 s27, 0
    s_cbranch_scc1 parallel_sum__softmax_full_mha__glu_gated_swiglu__prompt_kernel_loop
    v_mfma_f32_32x32x16_bf16 v[120:135], v[48:51], v[64:67], v[120:135]
    v_mfma_f32_32x32x16_bf16 v[120:135], v[52:55], v[68:71], v[120:135]
    s_lshl_b32 s3, s12, 12
    v_add_u32 v6, s3, v136
    v_mov_b32 v1, 0x5d800000
    s_lshl_b32 s3, s28, 5
    s_add_u32 s3, s3, s10
    s_lshl_b32 s29, s3, 10
    s_add_u32 s29, s29, 16777216
    s_lshl_b32 s37, s3, 8
    s_add_u32 s37, s37, 18874368
    s_lshl_b32 s38, s11, 5
    s_add_u32 s38, s38, s10
    s_lshl_b32 s38, s38, 4
    s_add_u32 s38, s38, 19398656
    s_waitcnt lgkmcnt(0)
    v_cmp_nle_f32 vcc, v112, v1
    v_cmp_nle_f32 s[30:31], v128, v1
    ds_write_b128 v6, v[120:123] offset:0
    ds_write_b128 v6, v[124:127] offset:1024
    ds_write_b128 v6, v[128:131] offset:2048
    ds_write_b32 v6, v5 offset:3072
    s_or_b32 s30, s31, vcc_hi
    v_mov_b32 v1, 155888
    s_cmp_eq_u32 s30, 0
    s_cbranch_scc1 parallel_sum__softmax_full_mha__glu_gated_swiglu__prompt_kernel_noflag
    v_mov_b32 v56, 1
    ds_write_b32 v1, v56
parallel_sum__softmax_full_mha__glu_gated_swiglu__prompt_kernel_noflag:
    v_add_u32 v138, 1, v138
    ds_write_b32 v139, v138
    ds_read_b32 v141, v140
    s_waitcnt lgkmcnt(0)
    v_cmp_lt_u32 vcc, v141, v138
    s_cbranch_vccnz parallel_sum__softmax_full_mha__glu_gated_swiglu__prompt_kernel_sb2s
parallel_sum__softmax_full_mha__glu_gated_swiglu__prompt_kernel_sb2r:
    ds_read_b32 v1, v1
    v_xor_b32 v6, 0x4000, v6
    ds_read_b32 v84, v6 offset:3072
    ds_read_b128 v[80:83], v6 offset:2048
    ds_read_b128 v[72:75], v6 offset:0
    ds_read_b128 v[76:79], v6 offset:1024
    s_waitcnt lgkmcnt(3)
    v_readfirstlane_b32 s30, v1
    v_max_f32 v1, v4, v84
    v_sub_f32 v56, v4, v1
    v_sub_f32 v57, v84, v1
    s_andn2_b32 s30, s30, s26
    s_cmp_lg_u32 s30, 0
    s_cbranch_scc1 parallel_sum__softmax_full_mha__glu_gated_swiglu__prompt_kernel_slow
    v_exp_f32 v56, v56
    v_exp_f32 v57, v57
    s_waitcnt lgkmcnt(2)
    v_mul_f32 v1, v112, v56
    v_fmac_f32 v1, v80, v57
    v_mov_b32 v6, v1
    s_nop 0
    s_nop 0
    v_permlane32_swap_b32 v1, v6
    v_rcp_f32 v6, v6
    v_lshlrev_b32 v1, 3, v0
    v_mul_f32 v56, v56, v6
    v_mul_f32 v57, v57, v6
    s_waitcnt lgkmcnt(0)
    v_mul_f32 v104, v104, v56
    v_mul_f32 v105, v105, v56
    v_mul_f32 v106, v106, v56
    v_mul_f32 v107, v107, v56
    v_mul_f32 v108, v108, v56
    v_mul_f32 v109, v109, v56
    v_mul_f32 v110, v110, v56
    v_mul_f32 v111, v111, v56
    v_mul_f32 v112, v112, v56
    v_mul_f32 v113, v113, v56
    v_mul_f32 v114, v114, v56
    v_mul_f32 v115, v115, v56
    v_fmac_f32 v104, v72, v57
    v_fmac_f32 v105, v73, v57
    v_fmac_f32 v106, v74, v57
    v_fmac_f32 v107, v75, v57
    v_fmac_f32 v108, v76, v57
    v_fmac_f32 v109, v77, v57
    v_fmac_f32 v110, v78, v57
    v_fmac_f32 v111, v79, v57
    v_fmac_f32 v112, v80, v57
    v_fmac_f32 v113, v81, v57
    v_fmac_f32 v114, v82, v57
    v_fmac_f32 v115, v83, v57
    v_cvt_pk_bf16_f32 v88, v104, v105
    v_cvt_pk_bf16_f32 v89, v106, v107
    v_cvt_pk_bf16_f32 v90, v108, v109
    v_cvt_pk_bf16_f32 v91, v110, v111
    v_cvt_pk_bf16_f32 v92, v112, v113
    v_cvt_pk_bf16_f32 v93, v114, v115
    buffer_store_dwordx4 v[88:91], v136, s[16:19], s29 offen sc1
    s_mov_b32 exec_hi, 0
    buffer_store_dwordx2 v[92:93], v1, s[16:19], s37 offen sc1
    s_waitcnt vmcnt(0)
    s_mov_b64 exec, 1
    v_mov_b32 v56, 155916
    v_mov_b32 v57, 1
    ds_add_rtn_u32 v57, v56, v57
    v_mov_b32 v56, 0
    v_mov_b32 v58, s99
    s_waitcnt lgkmcnt(0)
    v_cmp_eq_u32 vcc, 7, v57
    s_cbranch_vccz parallel_sum__softmax_full_mha__glu_gated_swiglu__prompt_kernel_sg3
    buffer_store_dword v58, v56, s[16:19], s38 offen sc1
parallel_sum__softmax_full_mha__glu_gated_swiglu__prompt_kernel_sg3:
    s_mov_b64 exec, -1
    s_endpgm
parallel_sum__softmax_full_mha__glu_gated_swiglu__prompt_kernel_slow:
    s_mov_b32 s26, 1
    s_waitcnt lgkmcnt(0)
    v_add_u32 v138, 1, v138
    ds_write_b32 v139, v138
    ds_read_b32 v141, v140
    s_waitcnt lgkmcnt(0)
    v_cmp_lt_u32 vcc, v141, v138
    s_cbranch_vccnz parallel_sum__softmax_full_mha__glu_gated_swiglu__prompt_kernel_sb3s
parallel_sum__softmax_full_mha__glu_gated_swiglu__prompt_kernel_sb3r:
    v_lshrrev_b32 v76, 4, v0
    v_lshlrev_b32 v76, 9, v76
    v_and_b32 v77, 15, v0
    v_min_u32 v77, 11, v77
    v_lshl_add_u32 v76, v77, 4, v76
    s_lshr_b32 s3, s12, 1
    s_lshl_b32 s3, s3, 13
    s_and_b32 s36, s12, 1
    s_lshl_b32 s36, s36, 11
    s_add_u32 s3, s3, s36
    v_add_u32 v76, s3, v76
    v_cmp_eq_u32 vcc, 0, v77
    v_mov_b32 v78, 0x3f803f80
    s_nop 0
    v_cndmask_b32 v72, 0, v78, vcc
    v_mov_b32 v73, v72
    v_mov_b32 v74, v72
    v_mov_b32 v75, v72
    ds_write_b128 v76, v[72:75] offset:3392
    s_lshr_b32 s3, s12, 1
    s_lshl_b32 s3, s3, 13
    v_mov_b32 v79, s3
    v_mov_b32 v80, 0x3f803f80
    v_mov_b32 v81, 0x3f80
    v_mov_b32 v82, 0x3f803f80
    v_mov_b32 v83, 0x3f80
    ds_write_b128 v79, v[80:83] offset:7168
    v_cmp_eq_u32 vcc, s13, v7
    s_nop 1
    v_cndmask_b32 v12, 0, v12, vcc
    v_cndmask_b32 v13, 0, v13, vcc
    v_mov_b32 v4, 0xff800000
    v_cmp_eq_u32 vcc, s13, v7
    s_nop 1
    v_cndmask_b32 v20, 0, v20, vcc
    v_cndmask_b32 v21, 0, v21, vcc
    v_mov_b32 v5, 0xff800000
    s_mul_i32 s36, s35, 80
    s_add_u32 s36, s36, s33
    s_add_u32 m0, s34, 3072
    s_mov_b32 exec_lo, 0x000fffff
    s_mov_b32 exec_hi, 0x000fffff
    buffer_load_dwordx4 v137, s[16:19], s36 offen sc1 lds
    s_mov_b64 exec, -1
    s_cmp_eq_u32 s24, 3
    s_cbranch_scc1 parallel_sum__softmax_full_mha__glu_gated_swiglu__prompt_kernel_kv3
    s_mov_b32 m0, s34
    s_add_u32 s36, s32, s35
    buffer_load_dwordx4 v136, s[16:19], s36 offen sc1 lds
parallel_sum__softmax_full_mha__glu_gated_swiglu__prompt_kernel_kv3:
    s_xor_b32 s34, s34, 16384
    s_add_u32 s35, s35, 1024
    s_and_b32 s35, s35, 0x3fff
    s_mov_b32 s27, 16
parallel_sum__softmax_full_mha__glu_gated_swiglu__prompt_kernel_maxloop:
    s_waitcnt vmcnt(0) lgkmcnt(0)
    v_add_u32 v138, 1, v138
    ds_write_b32 v139, v138
    ds_read_b32 v141, v140
    s_waitcnt lgkmcnt(0)
    v_cmp_lt_u32 vcc, v141, v138
    s_cbranch_vccnz parallel_sum__softmax_full_mha__glu_gated_swiglu__prompt_kernel_sb4s
parallel_sum__softmax_full_mha__glu_gated_swiglu__prompt_kernel_sb4r:
    s_mul_i32 s36, s35, 80
    s_add_u32 s36, s36, s33
    s_add_u32 m0, s34, 3072
    s_mov_b32 exec_lo, 0x000fffff
    s_mov_b32 exec_hi, 0x000fffff
    buffer_load_dwordx4 v137, s[16:19], s36 offen sc1 lds
    s_mov_b64 exec, -1
    s_cmp_eq_u32 s24, 3
    s_cbranch_scc1 parallel_sum__softmax_full_mha__glu_gated_swiglu__prompt_kernel_kv4
    s_mov_b32 m0, s34
    s_add_u32 s36, s32, s35
    buffer_load_dwordx4 v136, s[16:19], s36 offen sc1 lds
parallel_sum__softmax_full_mha__glu_gated_swiglu__prompt_kernel_kv4:
    s_xor_b32 s34, s34, 16384
    s_add_u32 s35, s35, 1024
    s_and_b32 s35, s35, 0x3fff
    ds_read2_b64 v[24:27], v3 offset0:0 offset1:128
    ds_read_b64 v[28:29], v2 offset:2048
    ds_read2_b64 v[32:35], v3 offset0:1 offset1:129
    ds_read_b64 v[36:37], v2 offset:2056
    v_xor_b32 v3, 16384, v3
    v_xor_b32 v2, 16384, v2
    s_waitcnt lgkmcnt(0)
    v_mfma_f32_32x32x8_bf16 v[72:87], v[28:29], v[12:13], 0
    v_mfma_f32_32x32x16_bf16 v[72:87], v[24:27], v[8:11], v[72:87]
    v_mfma_f32_32x32x8_bf16 v[88:103], v[28:29], v[20:21], 0
    v_mfma_f32_32x32x16_bf16 v[88:103], v[24:27], v[16:19], v[88:103]
    s_nop 8
    s_nop 0
    v_max3_f32 v4, v4, v72, v73
    v_max3_f32 v4, v4, v74, v75
    v_max3_f32 v4, v4, v76, v77
    v_max3_f32 v4, v4, v78, v79
    v_max3_f32 v4, v4, v80, v81
    v_max3_f32 v4, v4, v82, v83
    v_max3_f32 v4, v4, v84, v85
    v_max3_f32 v4, v4, v86, v87
    v_max3_f32 v5, v5, v88, v89
    v_max3_f32 v5, v5, v90, v91
    v_max3_f32 v5, v5, v92, v93
    v_max3_f32 v5, v5, v94, v95
    v_max3_f32 v5, v5, v96, v97
    v_max3_f32 v5, v5, v98, v99
    v_max3_f32 v5, v5, v100, v101
    v_max3_f32 v5, v5, v102, v103
    v_mfma_f32_32x32x8_bf16 v[72:87], v[36:37], v[12:13], 0
    v_mfma_f32_32x32x16_bf16 v[72:87], v[32:35], v[8:11], v[72:87]
    v_mfma_f32_32x32x8_bf16 v[88:103], v[36:37], v[20:21], 0
    v_mfma_f32_32x32x16_bf16 v[88:103], v[32:35], v[16:19], v[88:103]
    s_nop 8
    s_nop 0
    v_max3_f32 v4, v4, v72, v73
    v_max3_f32 v4, v4, v74, v75
    v_max3_f32 v4, v4, v76, v77
    v_max3_f32 v4, v4, v78, v79
    v_max3_f32 v4, v4, v80, v81
    v_max3_f32 v4, v4, v82, v83
    v_max3_f32 v4, v4, v84, v85
    v_max3_f32 v4, v4, v86, v87
    v_max3_f32 v5, v5, v88, v89
    v_max3_f32 v5, v5, v90, v91
    v_max3_f32 v5, v5, v92, v93
    v_max3_f32 v5, v5, v94, v95
    v_max3_f32 v5, v5, v96, v97
    v_max3_f32 v5, v5, v98, v99
    v_max3_f32 v5, v5, v100, v101
    v_max3_f32 v5, v5, v102, v103
    s_sub_u32 s27, s27, 1
    s_cmp_lg_u32 s27, 0
    s_cbranch_scc1 parallel_sum__softmax_full_mha__glu_gated_swiglu__prompt_kernel_maxloop
    v_cmp_eq_u32 vcc, s13, v7
    v_mov_b32 v1, v4
    s_nop 1
    v_permlane32_swap_b32 v4, v1
    v_max_f32 v4, v4, v1
    v_sub_f32 v1, 0, v4
    v_and_b32 v6, 0xffff0000, v1
    v_sub_f32 v1, v1, v6
    v_and_b32 v56, 0xffff0000, v1
    v_sub_f32 v1, v1, v56
    v_lshrrev_b32 v6, 16, v6
    v_or_b32 v6, v6, v56
    v_lshrrev_b32 v1, 16, v1
    v_cndmask_b32 v12, v6, v12, vcc
    v_cndmask_b32 v13, v1, v13, vcc
    v_mov_b32 v1, v5
    s_nop 1
    v_permlane32_swap_b32 v5, v1
    v_max_f32 v5, v5, v1
    v_sub_f32 v1, 0, v5
    v_and_b32 v6, 0xffff0000, v1
    v_sub_f32 v1, v1, v6
    v_and_b32 v56, 0xffff0000, v1
    v_sub_f32 v1, v1, v56
    v_lshrrev_b32 v6, 16, v6
    v_or_b32 v6, v6, v56
    v_lshrrev_b32 v1, 16, v1
    v_cndmask_b32 v20, v6, v20, vcc
    v_cndmask_b32 v21, v1, v21, vcc
    v_mov_b32 v104, 0
    v_mov_b32 v120, 0
    v_mov_b32 v105, 0
    v_mov_b32 v121, 0
    v_mov_b32 v106, 0
    v_mov_b32 v122, 0
    v_mov_b32 v107, 0
    v_mov_b32 v123, 0
    v_mov_b32 v108, 0
    v_mov_b32 v124, 0
    v_mov_b32 v109, 0
    v_mov_b32 v125, 0
    v_mov_b32 v110, 0
    v_mov_b32 v126, 0
    v_mov_b32 v111, 0
    v_mov_b32 v127, 0
    v_mov_b32 v112, 0
    v_mov_b32 v128, 0
    v_mov_b32 v113, 0
    v_mov_b32 v129, 0
    v_mov_b32 v114, 0
    v_mov_b32 v130, 0
    v_mov_b32 v115, 0
    v_mov_b32 v131, 0
    v_mov_b32 v116, 0
    v_mov_b32 v132, 0
    v_mov_b32 v117, 0
    v_mov_b32 v133, 0
    v_mov_b32 v118, 0
    v_mov_b32 v134, 0
    v_mov_b32 v119, 0
    v_mov_b32 v135, 0
    s_waitcnt vmcnt(0)
    v_add_u32 v138, 1, v138
    ds_write_b32 v139, v138
    ds_read_b32 v141, v140
    s_waitcnt lgkmcnt(0)
    v_cmp_lt_u32 vcc, v141, v138
    s_cbranch_vccnz parallel_sum__softmax_full_mha__glu_gated_swiglu__prompt_kernel_sb5s
parallel_sum__softmax_full_mha__glu_gated_swiglu__prompt_kernel_sb5r:
    ds_write_b32 v143, v142
    s_mul_i32 s36, s35, 80
    s_add_u32 s36, s36, s33
    s_add_u32 m0, s34, 3072
    s_mov_b32 exec_lo, 0x000fffff
    s_mov_b32 exec_hi, 0x000fffff
    buffer_load_dwordx4 v137, s[16:19], s36 offen sc1 lds
    s_mov_b64 exec, -1
    s_cmp_eq_u32 s24, 3
    s_cbranch_scc1 parallel_sum__softmax_full_mha__glu_gated_swiglu__prompt_kernel_kv5
    s_mov_b32 m0, s34
    s_add_u32 s36, s32, s35
    buffer_load_dwordx4 v136, s[16:19], s36 offen sc1 lds
parallel_sum__softmax_full_mha__glu_gated_swiglu__prompt_kernel_kv5:
    s_xor_b32 s34, s34, 16384
    s_add_u32 s35, s35, 1024
    s_and_b32 s35, s35, 0x3fff
    ds_read2_b64 v[24:27], v3 offset0:0 offset1:128
    ds_read_b64 v[28:29], v2 offset:2048
    s_waitcnt lgkmcnt(0)
    s_branch parallel_sum__softmax_full_mha__glu_gated_swiglu__prompt_kernel_restart
parallel_sum__softmax_full_mha__glu_gated_swiglu__prompt_kernel_sb0s:
    s_sleep 1
    ds_read_b32 v141, v140
    s_waitcnt lgkmcnt(0)
    v_cmp_lt_u32 vcc, v141, v138
    s_nop 1
    s_cbranch_vccnz parallel_sum__softmax_full_mha__glu_gated_swiglu__prompt_kernel_sb0s
    s_branch parallel_sum__softmax_full_mha__glu_gated_swiglu__prompt_kernel_sb0r
parallel_sum__softmax_full_mha__glu_gated_swiglu__prompt_kernel_sb1s:
    s_sleep 1
    ds_read_b32 v141, v140
    s_waitcnt lgkmcnt(0)
    v_cmp_lt_u32 vcc, v141, v138
    s_nop 1
    s_cbranch_vccnz parallel_sum__softmax_full_mha__glu_gated_swiglu__prompt_kernel_sb1s
    s_branch parallel_sum__softmax_full_mha__glu_gated_swiglu__prompt_kernel_sb1r
parallel_sum__softmax_full_mha__glu_gated_swiglu__prompt_kernel_sb2s:
    s_sleep 1
    ds_read_b32 v141, v140
    s_waitcnt lgkmcnt(0)
    v_cmp_lt_u32 vcc, v141, v138
    s_nop 1
    s_cbranch_vccnz parallel_sum__softmax_full_mha__glu_gated_swiglu__prompt_kernel_sb2s
    s_branch parallel_sum__softmax_full_mha__glu_gated_swiglu__prompt_kernel_sb2r
parallel_sum__softmax_full_mha__glu_gated_swiglu__prompt_kernel_sb3s:
    s_sleep 1
    ds_read_b32 v141, v140
    s_waitcnt lgkmcnt(0)
    v_cmp_lt_u32 vcc, v141, v138
    s_nop 1
    s_cbranch_vccnz parallel_sum__softmax_full_mha__glu_gated_swiglu__prompt_kernel_sb3s
    s_branch parallel_sum__softmax_full_mha__glu_gated_swiglu__prompt_kernel_sb3r
parallel_sum__softmax_full_mha__glu_gated_swiglu__prompt_kernel_sb4s:
    s_sleep 1
    ds_read_b32 v141, v140
    s_waitcnt lgkmcnt(0)
    v_cmp_lt_u32 vcc, v141, v138
    s_nop 1
    s_cbranch_vccnz parallel_sum__softmax_full_mha__glu_gated_swiglu__prompt_kernel_sb4s
    s_branch parallel_sum__softmax_full_mha__glu_gated_swiglu__prompt_kernel_sb4r
parallel_sum__softmax_full_mha__glu_gated_swiglu__prompt_kernel_sb5s:
    s_sleep 1
    ds_read_b32 v141, v140
    s_waitcnt lgkmcnt(0)
    v_cmp_lt_u32 vcc, v141, v138
    s_nop 1
    s_cbranch_vccnz parallel_sum__softmax_full_mha__glu_gated_swiglu__prompt_kernel_sb5s
    s_branch parallel_sum__softmax_full_mha__glu_gated_swiglu__prompt_kernel_sb5r
parallel_sum__softmax_full_mha__glu_gated_swiglu__prompt_kernel_end:
    s_endpgm
.section .rodata,"a"
.p2align 6
.amdhsa_kernel parallel_sum__softmax_full_mha__glu_gated_swiglu__prompt_kernel
  .amdhsa_next_free_vgpr 168
  .amdhsa_next_free_sgpr 102
  .amdhsa_accum_offset 168
  .amdhsa_group_segment_fixed_size 0
  .amdhsa_kernarg_size 80
  .amdhsa_user_sgpr_count 2
  .amdhsa_user_sgpr_kernarg_segment_ptr 1
  .amdhsa_system_sgpr_workgroup_id_x 1
.end_amdhsa_kernel
```
